```python
import torch

def _softmax(x, axis=-1):
    return torch.softmax(x, dim=axis)
def _gelu(x):
    return torch.nn.functional.gelu(x, approximate="tanh")
def _silu(x):
    return torch.nn.functional.silu(x)
def _sigmoid(x):
    return torch.sigmoid(x)
def _layernorm(x, axis=-1, eps=1e-5):
    m = x.mean(dim=axis, keepdim=True)
    v = x.var(dim=axis, keepdim=True, unbiased=False)
    return (x - m) / torch.sqrt(v + eps)
def _scatter_add(tgt, idx, src, axis=0):
    return tgt.clone().index_add_(axis, idx, src)
def _segment_sum(src, seg, n):
    out = torch.zeros((n,) + src.shape[1:], dtype=src.dtype)
    return out.index_add_(0, seg, src)
def _pad(x, pw):
    flat = tuple(v for pair in reversed(pw) for v in pair)
    return torch.nn.functional.pad(x, flat)

kernel_name = 'standalone__gqa_block_cached__near_ridge'

def setup_inputs():

    _w = (lambda a: (lambda t: t.to(torch.bfloat16) if t.is_floating_point() else t)(torch.as_tensor(a)))
    B, Sq, D = 8, 96, 640
    Hq, Hkv, Sk, Dh = 32, 32, 96, 192
    assert Hq % Hkv == 0, (Hq, Hkv)
    return {
        "x": _w((lambda *s: torch.randn(*s, dtype=torch.bfloat16) * 0.8)(B, Sq, D)),
        "k_cache": _w((lambda *s: torch.randn(*s, dtype=torch.bfloat16) * 0.8)(B, Hkv, Sk, Dh)),
        "v_cache": _w((lambda *s: torch.randn(*s, dtype=torch.bfloat16) * 0.05)(B, Hkv, Sk, Dh)),
        "wq": _w((lambda *s: torch.randn(*s, dtype=torch.bfloat16) * 0.8)(D, Hq * Dh) * (D ** -0.5)),
        "wo": _w((lambda *s: torch.randn(*s, dtype=torch.bfloat16) * 0.05)(Hq * Dh, D) * ((Hq * Dh) ** -0.5)),
    }

def reference(x, k_cache, v_cache, wq, wo):
    B, Sq, D = x.shape
    Hq, Dh = 32, 192
    Hkv = k_cache.shape[1]
    rep = Hq // Hkv
    q = (lambda x, *d: x.permute(*d))((x @ wq).reshape(B, Sq, Hq, Dh), 0, 2, 1, 3)
    k = (lambda x, n, axis: torch.repeat_interleave(x, n, dim=axis))(k_cache, rep, axis=1)
    v = (lambda x, n, axis: torch.repeat_interleave(x, n, dim=axis))(v_cache, rep, axis=1)
    scores = torch.einsum("bhqd,bhkd->bhqk", q, k) * (Dh ** -0.5)
    p = _softmax(scores, axis=-1)
    o = torch.einsum("bhqk,bhkd->bhqd", p, v)
    return (lambda x, *d: x.permute(*d))(o, 0, 2, 1, 3).reshape(B, Sq, Hq * Dh) @ wo
```

```asm
; @launch grid=(256,1,1) block=(512,1,1) lds=163840
.amdgcn_target "amdgcn-amd-amdhsa--gfx950"
.text
.globl standalone__gqa_block_cached__near_ridge_kernel
.p2align 8
.type standalone__gqa_block_cached__near_ridge_kernel,@function
standalone__gqa_block_cached__near_ridge_kernel:
    s_cmp_ge_u32 s2, 256
    s_cbranch_scc1 L_end
    s_load_dwordx16 s[32:47], s[0:1], 0
    v_lshrrev_b32 v1, 6, v0
    v_and_b32 v0, 63, v0
    v_readfirstlane_b32 s30, v1
    s_and_b32 s31, s2, 7
    s_lshr_b32 s4, s2, 3
    s_lshr_b32 s28, s4, 2
    s_and_b32 s48, s4, 3
    s_lshl_b32 s3, s31, 2
    s_add_u32 s29, s3, s48
    s_cmp_ge_u32 s30, 4
    s_cbranch_scc1 L_loader
    s_getpc_b64 s[62:63]
L_pc:
    s_sub_u32 s62, s62, L_pc-standalone__gqa_block_cached__near_ridge_kernel
    s_subb_u32 s63, s63, 0
    s_lshr_b32 s3, s2, 3
    s_and_b32 s3, s3, 3
    s_lshl_b32 s3, s3, 2
    s_add_u32 s3, s3, s30
    s_mul_i32 s3, s3, 7
    v_min_u32 v7, 6, v0
    v_add_u32 v7, s3, v7
    v_lshlrev_b32 v7, 7, v7
    v_min_u32 v7, L_last-standalone__gqa_block_cached__near_ridge_kernel, v7
    global_load_dword v14, v7, s[62:63]
    s_branch L_compute
L_loader:
    s_setprio 3
    s_sub_u32 s50, s30, 4
    v_add_u32 v4, 0, v0
    v_mul_u32_u24 v5, 2731, v4
    v_lshrrev_b32 v52, 16, v5
    v_mul_u32_u24 v5, 24, v52
    v_sub_u32 v55, v4, v5
    v_add_u32 v4, 64, v0
    v_mul_u32_u24 v5, 2731, v4
    v_lshrrev_b32 v53, 16, v5
    v_mul_u32_u24 v5, 24, v53
    v_sub_u32 v56, v4, v5
    v_add_u32 v4, 128, v0
    v_mul_u32_u24 v5, 2731, v4
    v_lshrrev_b32 v54, 16, v5
    v_mul_u32_u24 v5, 24, v54
    v_sub_u32 v57, v4, v5
    v_lshrrev_b32 v4, 4, v0
    v_xor_b32 v4, v4, v0
    v_and_b32 v4, 7, v4
    v_lshrrev_b32 v5, 3, v0
    v_mul_u32_u24 v5, 1280, v5
    v_lshl_add_u32 v4, v4, 4, v5
    s_and_b32 s3, s50, 1
    s_lshl_b32 s3, s3, 6
    s_mul_i32 s4, s50, 30720
    v_xor_b32 v4, s3, v4
    v_add_u32 v22, s4, v4
    v_xor_b32 v4, 64, v22
    v_add_u32 v23, 10240, v4
    v_add_u32 v24, 20480, v22
    s_lshl_b32 s3, s50, 4
    v_and_b32 v4, 2, v52
    v_xor_b32 v4, v4, v55
    v_add_u32 v5, s3, v52
    v_mul_u32_u24 v5, 12288, v5
    v_lshl_add_u32 v16, v4, 4, v5
    v_xor_b32 v4, 64, v16
    v_add_u32 v19, 98304, v4
    v_and_b32 v4, 2, v53
    v_xor_b32 v4, v4, v56
    v_add_u32 v5, s3, v53
    v_mul_u32_u24 v5, 12288, v5
    v_lshl_add_u32 v17, v4, 4, v5
    v_xor_b32 v4, 64, v17
    v_add_u32 v20, 98304, v4
    v_and_b32 v4, 2, v54
    v_xor_b32 v4, v4, v57
    v_add_u32 v5, s3, v54
    v_mul_u32_u24 v5, 12288, v5
    v_lshl_add_u32 v18, v4, 4, v5
    v_xor_b32 v4, 64, v18
    v_add_u32 v21, 98304, v4
    s_mul_i32 s62, s50, 6144
    s_mul_i32 s63, s50, 3072
    s_add_u32 s63, s63, 24576
    s_lshl_b32 s3, s28, 2
    s_lshr_b32 s3, 0x85308530, s3
    s_and_b32 s3, s3, 15
    s_lshl_b32 s4, s48, 2
    s_lshr_b32 s4, 0x8530, s4
    s_and_b32 s4, s4, 15
    s_add_u32 s3, s3, s4
    s_add_u32 s55, s3, s31
    s_sub_u32 s4, s55, 10
    s_cmp_ge_u32 s55, 10
    s_cselect_b32 s55, s4, s55
    s_sub_u32 s4, s55, 10
    s_cmp_ge_u32 s55, 10
    s_cselect_b32 s55, s4, s55
    s_mov_b32 s53, 0
    s_mul_i32 s3, s28, 122880
    s_mul_i32 s5, s29, 384
    s_sub_u32 s4, 7864320, s5
    s_waitcnt lgkmcnt(0)
    s_add_u32 s8, s32, s3
    s_addc_u32 s9, s33, 0
    s_mov_b32 s10, 122880
    s_mov_b32 s11, 0x20000
    s_add_u32 s12, s38, s5
    s_addc_u32 s13, s39, 0
    s_mov_b32 s14, s4
    s_mov_b32 s15, 0x20000
    s_mul_i32 s51, s55, 786432
    s_lshl_b32 s52, s55, 7
    s_add_u32 s3, s53, s62
    s_add_u32 s4, s53, s63
    s_add_u32 m0, s4, 0
    s_nop 0
    buffer_load_dwordx4 v22, s[8:11], s52 offen  lds
    s_add_u32 m0, s4, 1024
    s_nop 0
    buffer_load_dwordx4 v23, s[8:11], s52 offen  lds
    s_add_u32 m0, s4, 2048
    s_nop 0
    buffer_load_dwordx4 v24, s[8:11], s52 offen  lds
    s_add_u32 m0, s3, 0
    s_nop 0
    buffer_load_dwordx4 v16, s[12:15], s51 offen  lds
    s_add_u32 m0, s3, 1024
    s_nop 0
    buffer_load_dwordx4 v17, s[12:15], s51 offen  lds
    s_add_u32 m0, s3, 2048
    s_nop 0
    buffer_load_dwordx4 v18, s[12:15], s51 offen  lds
    s_add_u32 m0, s3, 3072
    s_nop 0
    buffer_load_dwordx4 v19, s[12:15], s51 offen  lds
    s_add_u32 m0, s3, 4096
    s_nop 0
    buffer_load_dwordx4 v20, s[12:15], s51 offen  lds
    s_add_u32 m0, s3, 5120
    s_nop 0
    buffer_load_dwordx4 v21, s[12:15], s51 offen  lds
    s_add_u32 s55, s55, 1
    s_cmp_eq_u32 s55, 10
    s_cselect_b32 s55, 0, s55
    s_add_u32 s53, s53, 36864
    s_cmp_eq_u32 s53, 110592
    s_cselect_b32 s53, 0, s53
    s_setprio 0
    s_lshl_b32 s3, s28, 7
    s_add_u32 s3, s3, 33685504
    s_add_u32 s4, s46, s3
    s_addc_u32 s5, s47, 0
    s_load_dwordx2 s[60:61], s[4:5], 0
    s_add_u32 s3, s28, s31
    s_and_b32 s3, s3, 7
    s_lshl_b32 s3, s3, 2
    s_lshr_b32 s3, 0x87654321, s3
    s_and_b32 s49, s3, 15
    s_lshl_b32 s3, s28, 5
    s_add_u32 s3, s3, s29
    s_mul_i32 s3, s3, 36864
    s_add_u32 s16, s34, s3
    s_addc_u32 s17, s35, 0
    s_mov_b32 s18, 36864
    s_mov_b32 s19, 0x20000
    s_add_u32 s20, s36, s3
    s_addc_u32 s21, s37, 0
    s_mov_b32 s22, 36864
    s_mov_b32 s23, 0x20000
    s_add_u32 s24, s46, 33554432
    s_addc_u32 s25, s47, 0
    s_mov_b32 s26, 262144
    s_mov_b32 s27, 0x20000
    s_mul_i32 s3, s50, 24
    s_and_b32 s4, s50, 1
    s_lshl_b32 s4, s4, 6
    v_lshrrev_b32 v4, 1, v52
    v_add_u32 v5, s3, v52
    v_mul_u32_u24 v5, 384, v5
    v_xor_b32 v6, v4, v55
    v_lshl_add_u32 v6, v6, 4, v5
    v_xor_b32 v25, s4, v6
    v_xor_b32 v6, 64, v25
    v_add_u32 v28, 3072, v6
    v_add_u32 v31, 6144, v25
    v_lshlrev_b32 v6, 1, v4
    v_xor_b32 v6, v6, v55
    v_lshl_add_u32 v34, v6, 4, v5
    v_add_u32 v37, 3072, v34
    v_add_u32 v40, 6144, v34
    v_lshrrev_b32 v4, 1, v53
    v_add_u32 v5, s3, v53
    v_mul_u32_u24 v5, 384, v5
    v_xor_b32 v6, v4, v56
    v_lshl_add_u32 v6, v6, 4, v5
    v_xor_b32 v26, s4, v6
    v_xor_b32 v6, 64, v26
    v_add_u32 v29, 3072, v6
    v_add_u32 v32, 6144, v26
    v_lshlrev_b32 v6, 1, v4
    v_xor_b32 v6, v6, v56
    v_lshl_add_u32 v35, v6, 4, v5
    v_add_u32 v38, 3072, v35
    v_add_u32 v41, 6144, v35
    v_lshrrev_b32 v4, 1, v54
    v_add_u32 v5, s3, v54
    v_mul_u32_u24 v5, 384, v5
    v_xor_b32 v6, v4, v57
    v_lshl_add_u32 v6, v6, 4, v5
    v_xor_b32 v27, s4, v6
    v_xor_b32 v6, 64, v27
    v_add_u32 v30, 3072, v6
    v_add_u32 v33, 6144, v27
    v_lshlrev_b32 v6, 1, v4
    v_xor_b32 v6, v6, v57
    v_lshl_add_u32 v36, v6, 4, v5
    v_add_u32 v39, 3072, v36
    v_add_u32 v42, 6144, v36
    s_mul_i32 s3, s31, 983040
    s_mul_i32 s4, s48, 320
    s_add_u32 s3, s3, s4
    s_sub_u32 s4, 7864320, s3
    s_add_u32 s56, s40, s3
    s_addc_u32 s57, s41, 0
    s_mov_b32 s58, s4
    s_mov_b32 s59, 0x20000
    s_lshr_b32 s3, s2, 3
    s_lshl_b32 s3, s3, 2
    s_add_u32 s3, s3, s50
    s_mul_i32 s3, s3, 7680
    v_min_u32 v4, 59, v0
    v_lshl_add_u32 v58, v4, 7, s3
    s_mul_i32 s51, s55, 786432
    s_lshl_b32 s52, s55, 7
    s_add_u32 s3, s53, s62
    s_add_u32 s4, s53, s63
    s_add_u32 m0, s4, 0
    s_nop 0
    buffer_load_dwordx4 v22, s[8:11], s52 offen  lds
    s_add_u32 m0, s4, 1024
    s_nop 0
    buffer_load_dwordx4 v23, s[8:11], s52 offen  lds
    s_add_u32 m0, s4, 2048
    s_nop 0
    buffer_load_dwordx4 v24, s[8:11], s52 offen  lds
    s_add_u32 m0, s3, 0
    s_nop 0
    buffer_load_dwordx4 v16, s[12:15], s51 offen  lds
    s_add_u32 m0, s3, 1024
    s_nop 0
    buffer_load_dwordx4 v17, s[12:15], s51 offen  lds
    s_add_u32 m0, s3, 2048
    s_nop 0
    buffer_load_dwordx4 v18, s[12:15], s51 offen  lds
    s_add_u32 m0, s3, 3072
    s_nop 0
    buffer_load_dwordx4 v19, s[12:15], s51 offen  lds
    s_add_u32 m0, s3, 4096
    s_nop 0
    buffer_load_dwordx4 v20, s[12:15], s51 offen  lds
    s_add_u32 m0, s3, 5120
    s_nop 0
    buffer_load_dwordx4 v21, s[12:15], s51 offen  lds
    s_add_u32 s55, s55, 1
    s_cmp_eq_u32 s55, 10
    s_cselect_b32 s55, 0, s55
    s_add_u32 s53, s53, 36864
    s_cmp_eq_u32 s53, 110592
    s_cselect_b32 s53, 0, s53
    s_waitcnt vmcnt(9)
    s_barrier
    s_mov_b32 s54, 0
L_lloop:
    s_cmp_eq_u32 s54, s49
    s_cbranch_scc0 L_nok
    s_call_b64 s[44:45], L_sub_k
L_nok:
    s_mul_i32 s51, s55, 786432
    s_lshl_b32 s52, s55, 7
    s_add_u32 s3, s53, s62
    s_add_u32 s4, s53, s63
    s_add_u32 m0, s4, 0
    s_nop 0
    buffer_load_dwordx4 v22, s[8:11], s52 offen  lds
    s_add_u32 m0, s4, 1024
    s_nop 0
    buffer_load_dwordx4 v23, s[8:11], s52 offen  lds
    s_add_u32 m0, s4, 2048
    s_nop 0
    buffer_load_dwordx4 v24, s[8:11], s52 offen  lds
    s_add_u32 m0, s3, 0
    s_nop 0
    buffer_load_dwordx4 v16, s[12:15], s51 offen  lds
    s_add_u32 m0, s3, 1024
    s_nop 0
    buffer_load_dwordx4 v17, s[12:15], s51 offen  lds
    s_add_u32 m0, s3, 2048
    s_nop 0
    buffer_load_dwordx4 v18, s[12:15], s51 offen  lds
    s_add_u32 m0, s3, 3072
    s_nop 0
    buffer_load_dwordx4 v19, s[12:15], s51 offen  lds
    s_add_u32 m0, s3, 4096
    s_nop 0
    buffer_load_dwordx4 v20, s[12:15], s51 offen  lds
    s_add_u32 m0, s3, 5120
    s_nop 0
    buffer_load_dwordx4 v21, s[12:15], s51 offen  lds
    s_add_u32 s55, s55, 1
    s_cmp_eq_u32 s55, 10
    s_cselect_b32 s55, 0, s55
    s_add_u32 s53, s53, 36864
    s_cmp_eq_u32 s53, 110592
    s_cselect_b32 s53, 0, s53
    s_waitcnt vmcnt(9)
    s_barrier
    s_add_u32 s54, s54, 1
    s_cmp_lt_u32 s54, 8
    s_cbranch_scc1 L_lloop
    s_cmp_eq_u32 s49, 8
    s_cbranch_scc0 L_vonly
    s_call_b64 s[44:45], L_sub_k
    s_waitcnt vmcnt(9)
    s_barrier
    s_call_b64 s[44:45], L_sub_v
    s_branch L_kvdone
L_sub_k:
    s_mul_i32 s3, s50, 9216
    s_add_u32 s3, s3, 110592
    s_add_u32 m0, s3, 0
    s_nop 0
    buffer_load_dwordx4 v25, s[16:19], 0 offen nt lds
    s_add_u32 m0, s3, 1024
    s_nop 0
    buffer_load_dwordx4 v26, s[16:19], 0 offen nt lds
    s_add_u32 m0, s3, 2048
    s_nop 0
    buffer_load_dwordx4 v27, s[16:19], 0 offen nt lds
    s_add_u32 m0, s3, 3072
    s_nop 0
    buffer_load_dwordx4 v28, s[16:19], 0 offen nt lds
    s_add_u32 m0, s3, 4096
    s_nop 0
    buffer_load_dwordx4 v29, s[16:19], 0 offen nt lds
    s_add_u32 m0, s3, 5120
    s_nop 0
    buffer_load_dwordx4 v30, s[16:19], 0 offen nt lds
    s_add_u32 m0, s3, 6144
    s_nop 0
    buffer_load_dwordx4 v31, s[16:19], 0 offen nt lds
    s_add_u32 m0, s3, 7168
    s_nop 0
    buffer_load_dwordx4 v32, s[16:19], 0 offen nt lds
    s_add_u32 m0, s3, 8192
    s_nop 0
    buffer_load_dwordx4 v33, s[16:19], 0 offen nt lds
    s_setpc_b64 s[44:45]
L_sub_v:
    s_mul_i32 s3, s50, 9216
    s_add_u32 s3, s3, 36864
    s_add_u32 m0, s3, 0
    s_nop 0
    buffer_load_dwordx4 v34, s[20:23], 0 offen nt lds
    s_add_u32 m0, s3, 1024
    s_nop 0
    buffer_load_dwordx4 v35, s[20:23], 0 offen nt lds
    s_add_u32 m0, s3, 2048
    s_nop 0
    buffer_load_dwordx4 v36, s[20:23], 0 offen nt lds
    s_add_u32 m0, s3, 3072
    s_nop 0
    buffer_load_dwordx4 v37, s[20:23], 0 offen nt lds
    s_add_u32 m0, s3, 4096
    s_nop 0
    buffer_load_dwordx4 v38, s[20:23], 0 offen nt lds
    s_add_u32 m0, s3, 5120
    s_nop 0
    buffer_load_dwordx4 v39, s[20:23], 0 offen nt lds
    s_add_u32 m0, s3, 6144
    s_nop 0
    buffer_load_dwordx4 v40, s[20:23], 0 offen nt lds
    s_add_u32 m0, s3, 7168
    s_nop 0
    buffer_load_dwordx4 v41, s[20:23], 0 offen nt lds
    s_add_u32 m0, s3, 8192
    s_nop 0
    buffer_load_dwordx4 v42, s[20:23], 0 offen nt lds
    s_setpc_b64 s[44:45]
L_sub_wo:
    s_mul_i32 s51, s55, 81920
    s_add_u32 s3, s53, s62
    s_add_u32 m0, s3, 0
    s_nop 0
    buffer_load_dwordx4 v43, s[56:59], s51 offen  lds
    s_add_u32 m0, s3, 1024
    s_nop 0
    buffer_load_dwordx4 v44, s[56:59], s51 offen  lds
    s_add_u32 m0, s3, 2048
    s_nop 0
    buffer_load_dwordx4 v45, s[56:59], s51 offen  lds
    s_add_u32 m0, s3, 3072
    s_nop 0
    buffer_load_dwordx4 v46, s[56:59], s51 offen  lds
    s_add_u32 m0, s3, 4096
    s_nop 0
    buffer_load_dwordx4 v47, s[56:59], s51 offen  lds
    s_add_u32 s55, s55, 1
    s_cmp_eq_u32 s55, 12
    s_cselect_b32 s55, 0, s55
    s_add_u32 s53, s53, 20480
    s_cmp_eq_u32 s53, 81920
    s_cselect_b32 s53, 0, s53
    s_setpc_b64 s[44:45]
L_sub_o:
    s_mul_i32 s52, s49, 12288
    s_add_u32 m0, s7, s63
    s_add_u32 s49, s49, 1
    buffer_load_dwordx4 v48, s[12:15], s52 offen offset:0 sc1  lds
    buffer_load_dwordx4 v48, s[12:15], s52 offen offset:1024 sc1  lds
    buffer_load_dwordx4 v48, s[12:15], s52 offen offset:2048 sc1  lds
    s_cmp_eq_u32 s49, 12
    s_cselect_b32 s49, 0, s49
    s_add_u32 s7, s7, 12288
    s_cmp_eq_u32 s7, 73728
    s_cselect_b32 s7, 0, s7
    s_setpc_b64 s[44:45]
L_vonly:
    s_call_b64 s[44:45], L_sub_v
    s_waitcnt vmcnt(9)
    s_barrier
L_kvdone:
    s_waitcnt vmcnt(9)
    s_barrier
    s_mul_i32 s3, s31, 983040
    s_add_u32 s8, s40, s3
    s_addc_u32 s9, s41, 0
    s_mov_b32 s10, 983040
    s_mov_b32 s11, 0x20000
    buffer_load_dword v74, v58, s[8:11], 0 offen
    s_lshl_b32 s3, s28, 3
    s_add_u32 s3, s3, s31
    s_mul_i32 s3, s3, 147456
    s_add_u32 s12, s46, s3
    s_addc_u32 s13, s47, 0
    s_mov_b32 s14, 147456
    s_mov_b32 s15, 0x20000
    s_lshl_b32 s3, s28, 2
    s_add_u32 s3, s3, s48
    s_mul_i32 s3, s3, 245760
    s_add_u32 s3, s3, 16777216
    s_add_u32 s16, s46, s3
    s_addc_u32 s17, s47, 0
    s_mov_b32 s18, 245760
    s_mov_b32 s19, 0x20000
    s_mul_i32 s62, s50, 5120
    s_add_u32 s62, s62, 81920
    s_mul_i32 s63, s50, 3072
    s_mul_i32 s55, s48, 3
    s_add_u32 s49, s55, 3
    s_cmp_eq_u32 s49, 12
    s_cselect_b32 s49, 0, s49
    s_mov_b32 s53, 20480
    s_mov_b32 s7, 36864
    s_barrier
    s_lshl_b32 s3, s50, 4
    v_add_u32 v4, 0, v0
    v_mul_u32_u24 v5, 3277, v4
    v_lshrrev_b32 v5, 16, v5
    v_mul_u32_u24 v6, 20, v5
    v_sub_u32 v4, v4, v6
    v_lshrrev_b32 v6, 1, v5
    v_and_b32 v6, 2, v6
    v_xor_b32 v4, v4, v6
    v_add_u32 v5, s3, v5
    v_mul_u32_u24 v5, 1280, v5
    v_lshl_add_u32 v43, v4, 4, v5
    v_add_u32 v4, 64, v0
    v_mul_u32_u24 v5, 3277, v4
    v_lshrrev_b32 v5, 16, v5
    v_mul_u32_u24 v6, 20, v5
    v_sub_u32 v4, v4, v6
    v_lshrrev_b32 v6, 1, v5
    v_and_b32 v6, 2, v6
    v_xor_b32 v4, v4, v6
    v_add_u32 v5, s3, v5
    v_mul_u32_u24 v5, 1280, v5
    v_lshl_add_u32 v44, v4, 4, v5
    v_add_u32 v4, 128, v0
    v_mul_u32_u24 v5, 3277, v4
    v_lshrrev_b32 v5, 16, v5
    v_mul_u32_u24 v6, 20, v5
    v_sub_u32 v4, v4, v6
    v_lshrrev_b32 v6, 1, v5
    v_and_b32 v6, 2, v6
    v_xor_b32 v4, v4, v6
    v_add_u32 v5, s3, v5
    v_mul_u32_u24 v5, 1280, v5
    v_lshl_add_u32 v45, v4, 4, v5
    v_add_u32 v4, 192, v0
    v_mul_u32_u24 v5, 3277, v4
    v_lshrrev_b32 v5, 16, v5
    v_mul_u32_u24 v6, 20, v5
    v_sub_u32 v4, v4, v6
    v_lshrrev_b32 v6, 1, v5
    v_and_b32 v6, 2, v6
    v_xor_b32 v4, v4, v6
    v_add_u32 v5, s3, v5
    v_mul_u32_u24 v5, 1280, v5
    v_lshl_add_u32 v46, v4, 4, v5
    v_add_u32 v4, 256, v0
    v_mul_u32_u24 v5, 3277, v4
    v_lshrrev_b32 v5, 16, v5
    v_mul_u32_u24 v6, 20, v5
    v_sub_u32 v4, v4, v6
    v_lshrrev_b32 v6, 1, v5
    v_and_b32 v6, 2, v6
    v_xor_b32 v4, v4, v6
    v_add_u32 v5, s3, v5
    v_mul_u32_u24 v5, 1280, v5
    v_lshl_add_u32 v47, v4, 4, v5
    v_lshl_add_u32 v48, v0, 4, s63
    s_lshl_b32 s3, s28, 5
    s_add_u32 s3, s3, s29
    s_lshr_b32 s3, s3, 2
    s_lshl_b32 s3, s3, 7
    v_and_b32 v4, 15, v0
    v_lshl_add_u32 v59, v4, 3, s3
    s_waitcnt lgkmcnt(0)
    s_add_u32 s60, s60, 0x9e3779b9
    s_addc_u32 s61, s61, 0x7f4a7c15
    v_mov_b32 v62, s60
    v_mov_b32 v63, s61
    v_mov_b32 v4, 163064
    ds_write_b64 v4, v[62:63]
    s_waitcnt vmcnt(1) lgkmcnt(0)
    s_barrier
    s_mul_i32 s3, s28, 122880
    s_mul_i32 s4, s48, 320
    s_add_u32 s3, s3, s4
    s_sub_u32 s4, 983040, s3
    s_add_u32 s20, s42, s3
    s_addc_u32 s21, s43, 0
    s_mov_b32 s22, s4
    s_mov_b32 s23, 0x20000
    s_barrier
    s_lshl_b32 s3, s48, 2
    s_lshl_b32 s3, 0x000f000f, s3
    s_not_b32 s40, s3
    s_mov_b32 s41, s40
    s_barrier
    s_call_b64 s[44:45], L_sub_wo
    s_waitcnt vmcnt(0)
    s_barrier
    s_call_b64 s[44:45], L_sub_wo
    s_call_b64 s[44:45], L_sub_wo
    s_waitcnt vmcnt(5)
    s_barrier
    buffer_load_dwordx2 v[64:65], v59, s[24:27], 0 offen sc1
    s_call_b64 s[44:45], L_sub_wo
    s_waitcnt vmcnt(6)
    s_barrier
    s_waitcnt vmcnt(5)
    v_cmp_ne_u64 vcc, v[64:65], v[62:63]
    s_nop 1
    s_and_b64 s[4:5], vcc, s[40:41]
    s_cbranch_scc0 L_path_b
    s_barrier
    s_call_b64 s[44:45], L_sub_wo
    s_call_b64 s[44:45], L_sub_wo
    s_mov_b32 s3, 2097152
L_poll1:
    buffer_load_dwordx2 v[64:65], v59, s[24:27], 0 offen sc1
    s_sub_u32 s3, s3, 1
    s_cmp_eq_u32 s3, 0
    s_cbranch_scc1 L_poll1_out
    s_waitcnt vmcnt(0)
    v_cmp_ne_u64 vcc, v[64:65], v[62:63]
    s_nop 1
    s_cbranch_vccnz L_poll1
L_poll1_out:
    s_waitcnt vmcnt(0)
    s_call_b64 s[44:45], L_sub_o
    s_call_b64 s[44:45], L_sub_o
    s_call_b64 s[44:45], L_sub_o
    s_waitcnt vmcnt(6)
    s_barrier
    s_call_b64 s[44:45], L_sub_wo
    s_call_b64 s[44:45], L_sub_o
    s_waitcnt vmcnt(11)
    s_barrier
    s_call_b64 s[44:45], L_sub_wo
    s_call_b64 s[44:45], L_sub_o
    s_waitcnt vmcnt(16)
    s_barrier
    s_call_b64 s[44:45], L_sub_wo
    s_call_b64 s[44:45], L_sub_o
    s_waitcnt vmcnt(16)
    s_barrier
    s_call_b64 s[44:45], L_sub_wo
    s_call_b64 s[44:45], L_sub_o
    s_waitcnt vmcnt(16)
    s_barrier
    s_call_b64 s[44:45], L_sub_wo
    s_call_b64 s[44:45], L_sub_o
    s_waitcnt vmcnt(16)
    s_barrier
    s_call_b64 s[44:45], L_sub_wo
    s_call_b64 s[44:45], L_sub_o
    s_waitcnt vmcnt(16)
    s_barrier
    s_waitcnt vmcnt(8)
    s_barrier
    s_waitcnt vmcnt(0)
    s_barrier
    s_branch L_final
L_path_b:
    s_call_b64 s[44:45], L_sub_o
    s_call_b64 s[44:45], L_sub_o
    s_call_b64 s[44:45], L_sub_o
    s_barrier
    s_call_b64 s[44:45], L_sub_wo
    s_waitcnt vmcnt(11)
    s_barrier
    s_call_b64 s[44:45], L_sub_wo
    s_call_b64 s[44:45], L_sub_o
    s_waitcnt vmcnt(8)
    s_barrier
    s_call_b64 s[44:45], L_sub_wo
    s_call_b64 s[44:45], L_sub_o
    s_waitcnt vmcnt(11)
    s_barrier
    s_call_b64 s[44:45], L_sub_wo
    s_call_b64 s[44:45], L_sub_o
    s_waitcnt vmcnt(11)
    s_barrier
    s_call_b64 s[44:45], L_sub_wo
    s_call_b64 s[44:45], L_sub_o
    s_waitcnt vmcnt(11)
    s_barrier
    s_call_b64 s[44:45], L_sub_wo
    s_call_b64 s[44:45], L_sub_o
    s_waitcnt vmcnt(11)
    s_barrier
    s_call_b64 s[44:45], L_sub_wo
    s_call_b64 s[44:45], L_sub_o
    s_waitcnt vmcnt(11)
    s_barrier
    s_call_b64 s[44:45], L_sub_wo
    s_waitcnt vmcnt(8)
    s_barrier
    s_waitcnt vmcnt(0)
    s_barrier
L_final:
    s_lshr_b32 s5, s31, 2
    s_lshl_b32 s3, s28, 5
    s_add_u32 s3, s3, s29
    s_lshl_b32 s3, s3, 7
    s_add_u32 s3, s3, 65536
    v_and_b32 v4, 15, v0
    v_lshl_add_u32 v60, v4, 3, s3
    s_and_b32 s6, s31, 3
    s_mul_i32 s6, s6, 3
    s_mul_i32 s5, s5, 7680
    s_mul_i32 s4, s31, 0
    s_cmp_eq_u32 s50, 3
    s_cbranch_scc1 L_red3
    s_add_u32 s6, s6, s50
    s_lshr_b32 s3, s6, 2
    s_mul_i32 s3, s3, 2560
    s_add_u32 s5, s5, s3
    s_and_b32 s6, s6, 3
    s_lshl_b32 s6, s6, 8
    s_add_u32 s5, s5, s6
    s_mul_i32 s3, s50, 1280
    s_add_u32 s4, s4, s3
    v_lshrrev_b32 v7, 5, v0
    v_bfe_u32 v8, v0, 4, 1
    v_mul_u32_u24 v9, 15360, v7
    v_lshl_add_u32 v9, v8, 10, v9
    v_lshl_add_u32 v9, v4, 4, v9
    v_add_u32 v68, s5, v9
    v_and_b32 v9, 3, v0
    v_mul_u32_u24 v9, 320, v9
    v_mul_u32_u24 v7, 160, v7
    v_lshl_add_u32 v7, v8, 6, v7
    v_bfe_u32 v8, v0, 2, 2
    v_lshl_add_u32 v7, v8, 3, v7
    v_add3_u32 v66, v7, v9, s4
    v_add_u32 v67, 32, v66
    s_branch L_red
L_red3:
    v_min_u32 v10, 47, v0
    v_lshrrev_b32 v7, 4, v10
    v_add_u32 v8, s6, v7
    v_lshrrev_b32 v9, 2, v8
    v_mul_u32_u24 v9, 2560, v9
    v_and_b32 v8, 3, v8
    v_lshl_add_u32 v9, v8, 7, v9
    v_bfe_u32 v8, v10, 3, 1
    v_mul_u32_u24 v11, 15360, v8
    v_add_u32 v9, v9, v11
    v_and_b32 v11, 7, v10
    v_lshl_add_u32 v9, v11, 4, v9
    s_add_u32 s5, s5, 2048
    v_add_u32 v68, s5, v9
    v_and_b32 v11, 1, v10
    v_lshl_add_u32 v7, v7, 1, v11
    v_mul_u32_u24 v7, 640, v7
    v_mul_u32_u24 v8, 160, v8
    v_bfe_u32 v11, v10, 1, 2
    v_lshl_add_u32 v8, v11, 3, v8
    s_add_u32 s4, s4, 128
    v_add3_u32 v66, v7, v8, s4
    v_add_u32 v67, 320, v66
L_red:
    s_lshl_b32 s4, s50, 6
    v_add_u32 v7, s4, v0
    v_min_u32 v7, 239, v7
    v_lshlrev_b32 v69, 4, v7
    v_mul_u32_u24 v8, 3277, v7
    v_lshrrev_b32 v8, 16, v8
    v_mul_u32_u24 v8, 960, v8
    s_mul_i32 s4, s31, 15360
    v_add3_u32 v70, v8, v69, s4
    s_barrier
    ds_read_b128 v[80:83], v68 offset:4096
    s_mov_b32 s3, 2097152
L_poll2:
    buffer_load_dwordx2 v[64:65], v60, s[24:27], 0 offen sc1
    s_sub_u32 s3, s3, 1
    s_cmp_eq_u32 s3, 0
    s_cbranch_scc1 L_poll2_out
    s_waitcnt vmcnt(0)
    v_cmp_ne_u64 vcc, v[64:65], v[62:63]
    s_nop 1
    s_cbranch_vccnz L_poll2
L_poll2_out:
    s_waitcnt vmcnt(0)
    s_mov_b32 s6, s31
    s_add_u32 s6, s6, 1
    s_and_b32 s6, s6, 7
    s_mul_i32 s3, s6, 30720
    buffer_load_dwordx4 v[84:87], v68, s[16:19], s3 offen sc1
    s_add_u32 s6, s6, 1
    s_and_b32 s6, s6, 7
    s_mul_i32 s3, s6, 30720
    buffer_load_dwordx4 v[88:91], v68, s[16:19], s3 offen sc1
    s_add_u32 s6, s6, 1
    s_and_b32 s6, s6, 7
    s_mul_i32 s3, s6, 30720
    buffer_load_dwordx4 v[92:95], v68, s[16:19], s3 offen sc1
    s_add_u32 s6, s6, 1
    s_and_b32 s6, s6, 7
    s_mul_i32 s3, s6, 30720
    buffer_load_dwordx4 v[96:99], v68, s[16:19], s3 offen sc1
    s_add_u32 s6, s6, 1
    s_and_b32 s6, s6, 7
    s_mul_i32 s3, s6, 30720
    buffer_load_dwordx4 v[100:103], v68, s[16:19], s3 offen sc1
    s_add_u32 s6, s6, 1
    s_and_b32 s6, s6, 7
    s_mul_i32 s3, s6, 30720
    buffer_load_dwordx4 v[104:107], v68, s[16:19], s3 offen sc1
    s_add_u32 s6, s6, 1
    s_and_b32 s6, s6, 7
    s_mul_i32 s3, s6, 30720
    buffer_load_dwordx4 v[108:111], v68, s[16:19], s3 offen sc1
    s_waitcnt lgkmcnt(0)
    v_lshlrev_b32 v148, 16, v80
    v_and_b32 v149, 0xffff0000, v80
    v_lshlrev_b32 v150, 16, v81
    v_and_b32 v151, 0xffff0000, v81
    v_lshlrev_b32 v152, 16, v82
    v_and_b32 v153, 0xffff0000, v82
    v_lshlrev_b32 v154, 16, v83
    v_and_b32 v155, 0xffff0000, v83
    s_waitcnt vmcnt(6)
    v_lshlrev_b32 v4, 16, v84
    v_and_b32 v5, 0xffff0000, v84
    v_pk_add_f32 v[148:149], v[148:149], v[4:5]
    v_lshlrev_b32 v6, 16, v85
    v_and_b32 v7, 0xffff0000, v85
    v_pk_add_f32 v[150:151], v[150:151], v[6:7]
    v_lshlrev_b32 v4, 16, v86
    v_and_b32 v5, 0xffff0000, v86
    v_pk_add_f32 v[152:153], v[152:153], v[4:5]
    v_lshlrev_b32 v6, 16, v87
    v_and_b32 v7, 0xffff0000, v87
    v_pk_add_f32 v[154:155], v[154:155], v[6:7]
    s_waitcnt vmcnt(5)
    v_lshlrev_b32 v4, 16, v88
    v_and_b32 v5, 0xffff0000, v88
    v_pk_add_f32 v[148:149], v[148:149], v[4:5]
    v_lshlrev_b32 v6, 16, v89
    v_and_b32 v7, 0xffff0000, v89
    v_pk_add_f32 v[150:151], v[150:151], v[6:7]
    v_lshlrev_b32 v4, 16, v90
    v_and_b32 v5, 0xffff0000, v90
    v_pk_add_f32 v[152:153], v[152:153], v[4:5]
    v_lshlrev_b32 v6, 16, v91
    v_and_b32 v7, 0xffff0000, v91
    v_pk_add_f32 v[154:155], v[154:155], v[6:7]
    s_waitcnt vmcnt(4)
    v_lshlrev_b32 v4, 16, v92
    v_and_b32 v5, 0xffff0000, v92
    v_pk_add_f32 v[148:149], v[148:149], v[4:5]
    v_lshlrev_b32 v6, 16, v93
    v_and_b32 v7, 0xffff0000, v93
    v_pk_add_f32 v[150:151], v[150:151], v[6:7]
    v_lshlrev_b32 v4, 16, v94
    v_and_b32 v5, 0xffff0000, v94
    v_pk_add_f32 v[152:153], v[152:153], v[4:5]
    v_lshlrev_b32 v6, 16, v95
    v_and_b32 v7, 0xffff0000, v95
    v_pk_add_f32 v[154:155], v[154:155], v[6:7]
    s_waitcnt vmcnt(3)
    v_lshlrev_b32 v4, 16, v96
    v_and_b32 v5, 0xffff0000, v96
    v_pk_add_f32 v[148:149], v[148:149], v[4:5]
    v_lshlrev_b32 v6, 16, v97
    v_and_b32 v7, 0xffff0000, v97
    v_pk_add_f32 v[150:151], v[150:151], v[6:7]
    v_lshlrev_b32 v4, 16, v98
    v_and_b32 v5, 0xffff0000, v98
    v_pk_add_f32 v[152:153], v[152:153], v[4:5]
    v_lshlrev_b32 v6, 16, v99
    v_and_b32 v7, 0xffff0000, v99
    v_pk_add_f32 v[154:155], v[154:155], v[6:7]
    s_waitcnt vmcnt(2)
    v_lshlrev_b32 v4, 16, v100
    v_and_b32 v5, 0xffff0000, v100
    v_pk_add_f32 v[148:149], v[148:149], v[4:5]
    v_lshlrev_b32 v6, 16, v101
    v_and_b32 v7, 0xffff0000, v101
    v_pk_add_f32 v[150:151], v[150:151], v[6:7]
    v_lshlrev_b32 v4, 16, v102
    v_and_b32 v5, 0xffff0000, v102
    v_pk_add_f32 v[152:153], v[152:153], v[4:5]
    v_lshlrev_b32 v6, 16, v103
    v_and_b32 v7, 0xffff0000, v103
    v_pk_add_f32 v[154:155], v[154:155], v[6:7]
    s_waitcnt vmcnt(1)
    v_lshlrev_b32 v4, 16, v104
    v_and_b32 v5, 0xffff0000, v104
    v_pk_add_f32 v[148:149], v[148:149], v[4:5]
    v_lshlrev_b32 v6, 16, v105
    v_and_b32 v7, 0xffff0000, v105
    v_pk_add_f32 v[150:151], v[150:151], v[6:7]
    v_lshlrev_b32 v4, 16, v106
    v_and_b32 v5, 0xffff0000, v106
    v_pk_add_f32 v[152:153], v[152:153], v[4:5]
    v_lshlrev_b32 v6, 16, v107
    v_and_b32 v7, 0xffff0000, v107
    v_pk_add_f32 v[154:155], v[154:155], v[6:7]
    s_waitcnt vmcnt(0)
    v_lshlrev_b32 v4, 16, v108
    v_and_b32 v5, 0xffff0000, v108
    v_pk_add_f32 v[148:149], v[148:149], v[4:5]
    v_lshlrev_b32 v6, 16, v109
    v_and_b32 v7, 0xffff0000, v109
    v_pk_add_f32 v[150:151], v[150:151], v[6:7]
    v_lshlrev_b32 v4, 16, v110
    v_and_b32 v5, 0xffff0000, v110
    v_pk_add_f32 v[152:153], v[152:153], v[4:5]
    v_lshlrev_b32 v6, 16, v111
    v_and_b32 v7, 0xffff0000, v111
    v_pk_add_f32 v[154:155], v[154:155], v[6:7]
    v_cvt_pk_bf16_f32 v80, v148, v149
    v_cvt_pk_bf16_f32 v81, v150, v151
    v_cvt_pk_bf16_f32 v82, v152, v153
    v_cvt_pk_bf16_f32 v83, v154, v155
    ds_write_b64 v66, v[80:81]
    ds_write_b64 v67, v[82:83]
    s_waitcnt lgkmcnt(0)
    s_barrier
    ds_read_b128 v[84:87], v69
    s_waitcnt lgkmcnt(0)
    buffer_store_dwordx4 v[84:87], v70, s[20:23], 0 offen
    s_or_b32 s3, s29, s50
    s_cmp_eq_u32 s3, 0
    s_cbranch_scc0 L_noep
    s_lshl_b32 s3, s28, 7
    s_add_u32 s3, s3, 131072
    v_mov_b32 v4, 0
    s_mov_b64 exec, 1
    buffer_store_dwordx2 v[62:63], v4, s[24:27], s3 offen
L_noep:
L_end:
    s_endpgm
L_compute:
    s_lshr_b32 s50, s30, 1
    s_and_b32 s51, s30, 1
    s_mov_b32 s52, 0x3dd53b95
    s_mov_b32 s53, 0x3dd53b95
    v_and_b32 v1, 15, v0
    v_lshrrev_b32 v2, 4, v0
    v_lshrrev_b32 v4, 2, v1
    v_lshl_add_u32 v5, v2, 3, v4
    v_mul_u32_u24 v5, 384, v5
    v_and_b32 v6, 3, v1
    v_lshlrev_b32 v11, 3, v6
    v_add_u32 v5, v11, v5
    v_and_b32 v6, 1, v2
    v_lshrrev_b32 v3, 3, v1
    v_lshl_or_b32 v3, v6, 1, v3
    s_mul_i32 s3, s50, 6
    s_add_u32 s4, s3, 0
    s_and_b32 s5, s4, 3
    s_lshr_b32 s4, s4, 2
    s_lshl_b32 s4, s4, 7
    v_xor_b32 v6, s5, v3
    v_lshl_add_u32 v6, v6, 5, v5
    v_add_u32 v212, s4, v6
    s_add_u32 s4, s3, 1
    s_and_b32 s5, s4, 3
    s_lshr_b32 s4, s4, 2
    s_lshl_b32 s4, s4, 7
    v_xor_b32 v6, s5, v3
    v_lshl_add_u32 v6, v6, 5, v5
    v_add_u32 v213, s4, v6
    s_add_u32 s4, s3, 2
    s_and_b32 s5, s4, 3
    s_lshr_b32 s4, s4, 2
    s_lshl_b32 s4, s4, 7
    v_xor_b32 v6, s5, v3
    v_lshl_add_u32 v6, v6, 5, v5
    v_add_u32 v214, s4, v6
    s_add_u32 s4, s3, 3
    s_and_b32 s5, s4, 3
    s_lshr_b32 s4, s4, 2
    s_lshl_b32 s4, s4, 7
    v_xor_b32 v6, s5, v3
    v_lshl_add_u32 v6, v6, 5, v5
    v_add_u32 v215, s4, v6
    s_mul_i32 s4, s51, 48
    v_add_u32 v5, s4, v1
    v_lshlrev_b32 v5, 7, v5
    v_add_u32 v5, 24576, v5
    v_lshrrev_b32 v3, 1, v1
    v_add_u32 v6, 0, v2
    v_xor_b32 v6, v6, v3
    v_lshl_add_u32 v216, v6, 4, v5
    v_add_u32 v6, 4, v2
    v_xor_b32 v6, v6, v3
    v_lshl_add_u32 v217, v6, 4, v5
    v_mov_b32 v16, 0
    v_mov_b32 v17, 0
    v_mov_b32 v18, 0
    v_mov_b32 v19, 0
    v_mov_b32 v20, 0
    v_mov_b32 v21, 0
    v_mov_b32 v22, 0
    v_mov_b32 v23, 0
    v_mov_b32 v24, 0
    v_mov_b32 v25, 0
    v_mov_b32 v26, 0
    v_mov_b32 v27, 0
    v_mov_b32 v28, 0
    v_mov_b32 v29, 0
    v_mov_b32 v30, 0
    v_mov_b32 v31, 0
    v_mov_b32 v32, 0
    v_mov_b32 v33, 0
    v_mov_b32 v34, 0
    v_mov_b32 v35, 0
    v_mov_b32 v36, 0
    v_mov_b32 v37, 0
    v_mov_b32 v38, 0
    v_mov_b32 v39, 0
    v_mov_b32 v40, 0
    v_mov_b32 v41, 0
    v_mov_b32 v42, 0
    v_mov_b32 v43, 0
    v_mov_b32 v44, 0
    v_mov_b32 v45, 0
    v_mov_b32 v46, 0
    v_mov_b32 v47, 0
    v_mov_b32 v48, 0
    v_mov_b32 v49, 0
    v_mov_b32 v50, 0
    v_mov_b32 v51, 0
    v_mov_b32 v52, 0
    v_mov_b32 v53, 0
    v_mov_b32 v54, 0
    v_mov_b32 v55, 0
    v_mov_b32 v56, 0
    v_mov_b32 v57, 0
    v_mov_b32 v58, 0
    v_mov_b32 v59, 0
    v_mov_b32 v60, 0
    v_mov_b32 v61, 0
    v_mov_b32 v62, 0
    v_mov_b32 v63, 0
    v_mov_b32 v64, 0
    v_mov_b32 v65, 0
    v_mov_b32 v66, 0
    v_mov_b32 v67, 0
    v_mov_b32 v68, 0
    v_mov_b32 v69, 0
    v_mov_b32 v70, 0
    v_mov_b32 v71, 0
    v_mov_b32 v72, 0
    v_mov_b32 v73, 0
    v_mov_b32 v74, 0
    v_mov_b32 v75, 0
    v_mov_b32 v76, 0
    v_mov_b32 v77, 0
    v_mov_b32 v78, 0
    v_mov_b32 v79, 0
    v_mov_b32 v80, 0
    v_mov_b32 v81, 0
    v_mov_b32 v82, 0
    v_mov_b32 v83, 0
    v_mov_b32 v84, 0
    v_mov_b32 v85, 0
    v_mov_b32 v86, 0
    v_mov_b32 v87, 0
    s_mul_i32 s4, s50, 48
    v_add_u32 v5, s4, v1
    v_mul_u32_u24 v5, 384, v5
    v_and_b32 v6, 1, v2
    v_lshl_add_u32 v5, v6, 3, v5
    v_add_u32 v5, 110592, v5
    v_lshrrev_b32 v4, 1, v2
    v_xor_b32 v4, v4, v3
    v_lshl_add_u32 v5, v4, 4, v5
    s_mul_i32 s7, s50, 3
    s_add_u32 s6, s7, 0
    s_sub_u32 s4, s6, 6
    s_cmp_ge_u32 s6, 6
    s_cselect_b32 s6, s4, s6
    s_and_b32 s5, s6, 1
    s_lshl_b32 s5, s5, 6
    s_lshr_b32 s6, s6, 1
    s_lshl_b32 s6, s6, 7
    v_add_u32 v6, s6, v5
    v_xor_b32 v218, s5, v6
    v_xor_b32 v219, 32, v218
    s_add_u32 s6, s7, 1
    s_sub_u32 s4, s6, 6
    s_cmp_ge_u32 s6, 6
    s_cselect_b32 s6, s4, s6
    s_and_b32 s5, s6, 1
    s_lshl_b32 s5, s5, 6
    s_lshr_b32 s6, s6, 1
    s_lshl_b32 s6, s6, 7
    v_add_u32 v6, s6, v5
    v_xor_b32 v220, s5, v6
    v_xor_b32 v221, 32, v220
    s_add_u32 s6, s7, 2
    s_sub_u32 s4, s6, 6
    s_cmp_ge_u32 s6, 6
    s_cselect_b32 s6, s4, s6
    s_and_b32 s5, s6, 1
    s_lshl_b32 s5, s5, 6
    s_lshr_b32 s6, s6, 1
    s_lshl_b32 s6, s6, 7
    v_add_u32 v6, s6, v5
    v_xor_b32 v222, s5, v6
    v_xor_b32 v223, 32, v222
    s_add_u32 s6, s7, 3
    s_sub_u32 s4, s6, 6
    s_cmp_ge_u32 s6, 6
    s_cselect_b32 s6, s4, s6
    s_and_b32 s5, s6, 1
    s_lshl_b32 s5, s5, 6
    s_lshr_b32 s6, s6, 1
    s_lshl_b32 s6, s6, 7
    v_add_u32 v6, s6, v5
    v_xor_b32 v224, s5, v6
    v_xor_b32 v225, 32, v224
    s_add_u32 s6, s7, 4
    s_sub_u32 s4, s6, 6
    s_cmp_ge_u32 s6, 6
    s_cselect_b32 s6, s4, s6
    s_and_b32 s5, s6, 1
    s_lshl_b32 s5, s5, 6
    s_lshr_b32 s6, s6, 1
    s_lshl_b32 s6, s6, 7
    v_add_u32 v6, s6, v5
    v_xor_b32 v226, s5, v6
    v_xor_b32 v227, 32, v226
    s_add_u32 s6, s7, 5
    s_sub_u32 s4, s6, 6
    s_cmp_ge_u32 s6, 6
    s_cselect_b32 s6, s4, s6
    s_and_b32 s5, s6, 1
    s_lshl_b32 s5, s5, 6
    s_lshr_b32 s6, s6, 1
    s_lshl_b32 s6, s6, 7
    v_add_u32 v6, s6, v5
    v_xor_b32 v228, s5, v6
    v_xor_b32 v229, 32, v228
    v_lshrrev_b32 v4, 2, v1
    v_lshl_add_u32 v4, v2, 2, v4
    v_bfe_u32 v3, v4, 1, 2
    v_mul_u32_u24 v5, 384, v4
    v_add_u32 v5, v11, v5
    s_mul_i32 s6, s50, 18432
    s_add_u32 s7, s6, 36864
    v_add_u32 v5, s7, v5
    s_mul_i32 s3, s50, 6
    s_add_u32 s4, s3, 0
    s_and_b32 s5, s4, 3
    s_lshr_b32 s4, s4, 2
    s_lshl_b32 s4, s4, 7
    v_xor_b32 v6, s5, v3
    v_lshl_add_u32 v6, v6, 5, v5
    v_add_u32 v230, s4, v6
    s_add_u32 s4, s3, 1
    s_and_b32 s5, s4, 3
    s_lshr_b32 s4, s4, 2
    s_lshl_b32 s4, s4, 7
    v_xor_b32 v6, s5, v3
    v_lshl_add_u32 v6, v6, 5, v5
    v_add_u32 v231, s4, v6
    s_add_u32 s4, s3, 2
    s_and_b32 s5, s4, 3
    s_lshr_b32 s4, s4, 2
    s_lshl_b32 s4, s4, 7
    v_xor_b32 v6, s5, v3
    v_lshl_add_u32 v6, v6, 5, v5
    v_add_u32 v232, s4, v6
    s_add_u32 s4, s3, 3
    s_and_b32 s5, s4, 3
    s_lshr_b32 s4, s4, 2
    s_lshl_b32 s4, s4, 7
    v_xor_b32 v6, s5, v3
    v_lshl_add_u32 v6, v6, 5, v5
    v_add_u32 v233, s4, v6
    s_lshl_b32 s6, s6, 1
    s_sub_u32 s6, 18432, s6
    v_add_u32 v234, s6, v230
    v_add_u32 v235, s6, v231
    v_add_u32 v236, s6, v232
    v_add_u32 v237, s6, v233
    v_mul_u32_u24 v5, 320, v4
    v_add_u32 v5, v11, v5
    v_add_u32 v5, 102400, v5
    v_and_b32 v4, 1, v2
    s_mul_i32 s3, s50, 5
    s_add_u32 s4, s3, 0
    v_xor_b32 v6, s4, v4
    v_lshl_add_u32 v248, v6, 5, v5
    s_add_u32 s4, s3, 1
    v_xor_b32 v6, s4, v4
    v_lshl_add_u32 v249, v6, 5, v5
    s_xor_b32 s5, s30, 2
    v_lshlrev_b32 v5, 4, v0
    v_lshlrev_b32 v4, 3, v0
    v_lshlrev_b32 v6, 2, v1
    s_mul_i32 s3, s30, 9216
    s_add_u32 s3, s3, 73728
    v_add_u32 v238, s3, v5
    s_mul_i32 s3, s30, 4608
    s_add_u32 s3, s3, 73728
    v_add_u32 v242, s3, v5
    v_add_u32 v244, s3, v4
    s_mul_i32 s3, s30, 192
    s_add_u32 s3, s3, 163072
    v_add_u32 v240, s3, v6
    s_mul_i32 s3, s5, 9216
    s_add_u32 s3, s3, 73728
    v_add_u32 v239, s3, v5
    s_mul_i32 s3, s5, 4608
    s_add_u32 s3, s3, 73728
    v_add_u32 v243, s3, v5
    v_add_u32 v245, s3, v4
    s_mul_i32 s3, s5, 192
    s_add_u32 s3, s3, 163072
    v_add_u32 v241, s3, v6
    s_mul_i32 s3, s50, 18
    s_mul_i32 s4, s51, 3
    s_add_u32 s3, s3, s4
    s_lshl_b32 s3, s3, 10
    v_add_u32 v246, s3, v5
    s_mul_i32 s3, s51, 3072
    v_add_u32 v250, s3, v5
    v_lshrrev_b32 v12, 2, v1
    v_lshl_add_u32 v12, v12, 2, v2
    v_and_b32 v13, 3, v1
    v_lshl_add_u32 v12, v12, 2, v13
    s_mul_i32 s3, s30, 7680
    v_lshl_add_u32 v251, v12, 4, s3
    s_add_u32 s3, s3, 2048
    v_lshl_add_u32 v252, v12, 3, s3
    v_mov_b32 v247, 163064
    v_mov_b32 v208, 0x3f803f80
    v_mov_b32 v209, 0x3f803f80
    v_mov_b32 v210, 0x3f803f80
    v_mov_b32 v211, 0x3f803f80
    s_lshl_b32 s3, s28, 5
    s_add_u32 s3, s3, s29
    s_lshl_b32 s4, s48, 2
    s_add_u32 s4, s4, s30
    s_lshl_b32 s4, s4, 3
    s_andn2_b32 s5, s3, 3
    s_lshl_b32 s5, s5, 5
    s_add_u32 s16, s4, s5
    s_lshl_b32 s6, s50, 3
    s_add_u32 s6, s6, s31
    s_lshl_b32 s6, s6, 3
    s_lshl_b32 s5, s28, 5
    s_lshl_b32 s4, s51, 4
    s_add_u32 s5, s5, s4
    s_add_u32 s5, s5, s48
    s_lshl_b32 s5, s5, 7
    s_add_u32 s6, s6, s5
    s_add_u32 s17, s6, 65536
    v_lshlrev_b32 v15, 7, v0
    v_lshlrev_b32 v253, 9, v0
    s_lshl_b32 s4, s28, 2
    s_add_u32 s4, s4, s48
    s_lshl_b32 s4, s4, 3
    s_add_u32 s4, s4, s31
    s_mul_i32 s4, s4, 30720
    s_add_u32 s4, s4, 16777216
    s_mul_i32 s3, s3, 36864
    s_waitcnt lgkmcnt(0)
    s_add_u32 s8, s46, s3
    s_addc_u32 s9, s47, 0
    s_mov_b32 s10, 36864
    s_mov_b32 s11, 0x20000
    s_add_u32 s12, s46, s4
    s_addc_u32 s13, s47, 0
    s_mov_b32 s14, 30720
    s_mov_b32 s15, 0x20000
    s_add_u32 s24, s46, 33554432
    s_addc_u32 s25, s47, 0
    s_mov_b32 s26, 262144
    s_mov_b32 s27, 0x20000
    s_mov_b32 s56, 0
    s_mov_b32 s55, 0
    s_mov_b32 s58, 0xfffee000
    s_mov_b32 s59, 36864
    s_barrier
    ds_read_b128 v[112:115], v216 offset:0
    ds_read_b64_tr_b16 v[88:89], v212 offset:0
    ds_read_b64_tr_b16 v[90:91], v212 offset:1536
    ds_read_b128 v[116:119], v216 offset:2048
    ds_read_b128 v[120:123], v216 offset:4096
    ds_read_b64_tr_b16 v[92:93], v213 offset:0
    ds_read_b64_tr_b16 v[94:95], v213 offset:1536
    ds_read_b64_tr_b16 v[96:97], v214 offset:0
    ds_read_b64_tr_b16 v[98:99], v214 offset:1536
    ds_read_b64_tr_b16 v[100:101], v215 offset:0
    ds_read_b64_tr_b16 v[102:103], v215 offset:1536
    ds_read_b64_tr_b16 v[104:105], v212 offset:128
    ds_read_b64_tr_b16 v[106:107], v212 offset:1664
    ds_read_b64_tr_b16 v[108:109], v213 offset:128
    ds_read_b64_tr_b16 v[110:111], v213 offset:1664
    s_waitcnt lgkmcnt(0)
L_p1:
    v_mfma_f32_16x16x32_bf16 v[16:19], v[88:91], v[112:115], v[16:19]
    ds_read_b128 v[148:151], v217 offset:0
    s_add_u32 s56, s56, 1
    v_mfma_f32_16x16x32_bf16 v[20:23], v[88:91], v[116:119], v[20:23]
    ds_read_b64_tr_b16 v[124:125], v212 offset:12288
    s_cmp_eq_u32 s56, 3
    v_mfma_f32_16x16x32_bf16 v[24:27], v[88:91], v[120:123], v[24:27]
    ds_read_b64_tr_b16 v[126:127], v212 offset:13824
    s_cselect_b32 s54, s58, s59
    v_mfma_f32_16x16x32_bf16 v[28:31], v[92:95], v[112:115], v[28:31]
    ds_read_b128 v[152:155], v217 offset:2048
    s_cselect_b32 s56, 0, s56
    v_mfma_f32_16x16x32_bf16 v[32:35], v[92:95], v[116:119], v[32:35]
    ds_read_b128 v[156:159], v217 offset:4096
    v_mfma_f32_16x16x32_bf16 v[36:39], v[92:95], v[120:123], v[36:39]
    ds_read_b64_tr_b16 v[128:129], v213 offset:12288
    v_mfma_f32_16x16x32_bf16 v[40:43], v[96:99], v[112:115], v[40:43]
    ds_read_b64_tr_b16 v[130:131], v213 offset:13824
    v_mfma_f32_16x16x32_bf16 v[44:47], v[96:99], v[116:119], v[44:47]
    ds_read_b64_tr_b16 v[132:133], v214 offset:12288
    v_mfma_f32_16x16x32_bf16 v[48:51], v[96:99], v[120:123], v[48:51]
    ds_read_b64_tr_b16 v[134:135], v214 offset:13824
    v_mfma_f32_16x16x32_bf16 v[52:55], v[100:103], v[112:115], v[52:55]
    ds_read_b64_tr_b16 v[136:137], v215 offset:12288
    v_mfma_f32_16x16x32_bf16 v[56:59], v[100:103], v[116:119], v[56:59]
    ds_read_b64_tr_b16 v[138:139], v215 offset:13824
    v_mfma_f32_16x16x32_bf16 v[60:63], v[100:103], v[120:123], v[60:63]
    ds_read_b64_tr_b16 v[140:141], v212 offset:12416
    v_mfma_f32_16x16x32_bf16 v[64:67], v[104:107], v[112:115], v[64:67]
    ds_read_b64_tr_b16 v[142:143], v212 offset:13952
    v_mfma_f32_16x16x32_bf16 v[68:71], v[104:107], v[116:119], v[68:71]
    ds_read_b64_tr_b16 v[144:145], v213 offset:12416
    v_mfma_f32_16x16x32_bf16 v[72:75], v[104:107], v[120:123], v[72:75]
    ds_read_b64_tr_b16 v[146:147], v213 offset:13952
    v_mfma_f32_16x16x32_bf16 v[76:79], v[108:111], v[112:115], v[76:79]
    v_add_u32 v212, s54, v212
    v_add_u32 v213, s54, v213
    v_mfma_f32_16x16x32_bf16 v[80:83], v[108:111], v[116:119], v[80:83]
    v_add_u32 v214, s54, v214
    v_add_u32 v215, s54, v215
    v_mfma_f32_16x16x32_bf16 v[84:87], v[108:111], v[120:123], v[84:87]
    v_add_u32 v216, s54, v216
    v_add_u32 v217, s54, v217
    s_waitcnt lgkmcnt(0)
    s_barrier
    v_mfma_f32_16x16x32_bf16 v[16:19], v[124:127], v[148:151], v[16:19]
    ds_read_b128 v[112:115], v216 offset:0
    v_mfma_f32_16x16x32_bf16 v[20:23], v[124:127], v[152:155], v[20:23]
    ds_read_b64_tr_b16 v[88:89], v212 offset:0
    v_mfma_f32_16x16x32_bf16 v[24:27], v[124:127], v[156:159], v[24:27]
    ds_read_b64_tr_b16 v[90:91], v212 offset:1536
    v_mfma_f32_16x16x32_bf16 v[28:31], v[128:131], v[148:151], v[28:31]
    ds_read_b128 v[116:119], v216 offset:2048
    v_mfma_f32_16x16x32_bf16 v[32:35], v[128:131], v[152:155], v[32:35]
    ds_read_b128 v[120:123], v216 offset:4096
    v_mfma_f32_16x16x32_bf16 v[36:39], v[128:131], v[156:159], v[36:39]
    ds_read_b64_tr_b16 v[92:93], v213 offset:0
    v_mfma_f32_16x16x32_bf16 v[40:43], v[132:135], v[148:151], v[40:43]
    ds_read_b64_tr_b16 v[94:95], v213 offset:1536
    v_mfma_f32_16x16x32_bf16 v[44:47], v[132:135], v[152:155], v[44:47]
    ds_read_b64_tr_b16 v[96:97], v214 offset:0
    v_mfma_f32_16x16x32_bf16 v[48:51], v[132:135], v[156:159], v[48:51]
    ds_read_b64_tr_b16 v[98:99], v214 offset:1536
    v_mfma_f32_16x16x32_bf16 v[52:55], v[136:139], v[148:151], v[52:55]
    ds_read_b64_tr_b16 v[100:101], v215 offset:0
    v_mfma_f32_16x16x32_bf16 v[56:59], v[136:139], v[152:155], v[56:59]
    ds_read_b64_tr_b16 v[102:103], v215 offset:1536
    v_mfma_f32_16x16x32_bf16 v[60:63], v[136:139], v[156:159], v[60:63]
    ds_read_b64_tr_b16 v[104:105], v212 offset:128
    v_mfma_f32_16x16x32_bf16 v[64:67], v[140:143], v[148:151], v[64:67]
    ds_read_b64_tr_b16 v[106:107], v212 offset:1664
    v_mfma_f32_16x16x32_bf16 v[68:71], v[140:143], v[152:155], v[68:71]
    ds_read_b64_tr_b16 v[108:109], v213 offset:128
    v_mfma_f32_16x16x32_bf16 v[72:75], v[140:143], v[156:159], v[72:75]
    ds_read_b64_tr_b16 v[110:111], v213 offset:1664
    v_mfma_f32_16x16x32_bf16 v[76:79], v[144:147], v[148:151], v[76:79]
    s_add_u32 s55, s55, 1
    v_mfma_f32_16x16x32_bf16 v[80:83], v[144:147], v[152:155], v[80:83]
    s_cmp_lt_u32 s55, 8
    v_mfma_f32_16x16x32_bf16 v[84:87], v[144:147], v[156:159], v[84:87]
    s_waitcnt lgkmcnt(0)
    s_cbranch_scc1 L_p1
    v_mfma_f32_16x16x32_bf16 v[16:19], v[88:91], v[112:115], v[16:19]
    ds_read_b128 v[148:151], v217 offset:0
    v_mfma_f32_16x16x32_bf16 v[20:23], v[88:91], v[116:119], v[20:23]
    ds_read_b64_tr_b16 v[124:125], v212 offset:12288
    v_mfma_f32_16x16x32_bf16 v[24:27], v[88:91], v[120:123], v[24:27]
    ds_read_b64_tr_b16 v[126:127], v212 offset:13824
    v_mfma_f32_16x16x32_bf16 v[28:31], v[92:95], v[112:115], v[28:31]
    ds_read_b128 v[152:155], v217 offset:2048
    v_mfma_f32_16x16x32_bf16 v[32:35], v[92:95], v[116:119], v[32:35]
    ds_read_b128 v[156:159], v217 offset:4096
    v_mfma_f32_16x16x32_bf16 v[36:39], v[92:95], v[120:123], v[36:39]
    ds_read_b64_tr_b16 v[128:129], v213 offset:12288
    v_mfma_f32_16x16x32_bf16 v[40:43], v[96:99], v[112:115], v[40:43]
    ds_read_b64_tr_b16 v[130:131], v213 offset:13824
    v_mfma_f32_16x16x32_bf16 v[44:47], v[96:99], v[116:119], v[44:47]
    ds_read_b64_tr_b16 v[132:133], v214 offset:12288
    v_mfma_f32_16x16x32_bf16 v[48:51], v[96:99], v[120:123], v[48:51]
    ds_read_b64_tr_b16 v[134:135], v214 offset:13824
    v_mfma_f32_16x16x32_bf16 v[52:55], v[100:103], v[112:115], v[52:55]
    ds_read_b64_tr_b16 v[136:137], v215 offset:12288
    v_mfma_f32_16x16x32_bf16 v[56:59], v[100:103], v[116:119], v[56:59]
    ds_read_b64_tr_b16 v[138:139], v215 offset:13824
    v_mfma_f32_16x16x32_bf16 v[60:63], v[100:103], v[120:123], v[60:63]
    ds_read_b64_tr_b16 v[140:141], v212 offset:12416
    v_mfma_f32_16x16x32_bf16 v[64:67], v[104:107], v[112:115], v[64:67]
    ds_read_b64_tr_b16 v[142:143], v212 offset:13952
    v_mfma_f32_16x16x32_bf16 v[68:71], v[104:107], v[116:119], v[68:71]
    ds_read_b64_tr_b16 v[144:145], v213 offset:12416
    v_mfma_f32_16x16x32_bf16 v[72:75], v[104:107], v[120:123], v[72:75]
    ds_read_b64_tr_b16 v[146:147], v213 offset:13952
    v_mfma_f32_16x16x32_bf16 v[76:79], v[108:111], v[112:115], v[76:79]
    v_add_u32 v212, s58, v212
    v_add_u32 v213, s58, v213
    v_mfma_f32_16x16x32_bf16 v[80:83], v[108:111], v[116:119], v[80:83]
    v_add_u32 v214, s58, v214
    v_add_u32 v215, s58, v215
    v_mfma_f32_16x16x32_bf16 v[84:87], v[108:111], v[120:123], v[84:87]
    v_add_u32 v216, s58, v216
    v_add_u32 v217, s58, v217
    s_waitcnt lgkmcnt(0)
    v_mfma_f32_16x16x32_bf16 v[16:19], v[124:127], v[148:151], v[16:19]
    v_mfma_f32_16x16x32_bf16 v[20:23], v[124:127], v[152:155], v[20:23]
    v_mfma_f32_16x16x32_bf16 v[24:27], v[124:127], v[156:159], v[24:27]
    v_mfma_f32_16x16x32_bf16 v[28:31], v[128:131], v[148:151], v[28:31]
    v_mfma_f32_16x16x32_bf16 v[32:35], v[128:131], v[152:155], v[32:35]
    v_mfma_f32_16x16x32_bf16 v[36:39], v[128:131], v[156:159], v[36:39]
    v_mfma_f32_16x16x32_bf16 v[40:43], v[132:135], v[148:151], v[40:43]
    v_mfma_f32_16x16x32_bf16 v[44:47], v[132:135], v[152:155], v[44:47]
    v_mfma_f32_16x16x32_bf16 v[48:51], v[132:135], v[156:159], v[48:51]
    v_mfma_f32_16x16x32_bf16 v[52:55], v[136:139], v[148:151], v[52:55]
    v_mfma_f32_16x16x32_bf16 v[56:59], v[136:139], v[152:155], v[56:59]
    v_mfma_f32_16x16x32_bf16 v[60:63], v[136:139], v[156:159], v[60:63]
    s_barrier
    ds_read_b128 v[112:115], v216 offset:0
    ds_read_b64_tr_b16 v[88:89], v212 offset:0
    v_mfma_f32_16x16x32_bf16 v[64:67], v[140:143], v[148:151], v[64:67]
    ds_read_b64_tr_b16 v[90:91], v212 offset:1536
    ds_read_b128 v[116:119], v216 offset:2048
    v_mfma_f32_16x16x32_bf16 v[68:71], v[140:143], v[152:155], v[68:71]
    ds_read_b128 v[120:123], v216 offset:4096
    ds_read_b64_tr_b16 v[92:93], v213 offset:0
    v_mfma_f32_16x16x32_bf16 v[72:75], v[140:143], v[156:159], v[72:75]
    ds_read_b64_tr_b16 v[94:95], v213 offset:1536
    ds_read_b64_tr_b16 v[96:97], v214 offset:0
    v_mfma_f32_16x16x32_bf16 v[76:79], v[144:147], v[148:151], v[76:79]
    ds_read_b64_tr_b16 v[98:99], v214 offset:1536
    ds_read_b64_tr_b16 v[100:101], v215 offset:0
    v_mfma_f32_16x16x32_bf16 v[80:83], v[144:147], v[152:155], v[80:83]
    ds_read_b64_tr_b16 v[102:103], v215 offset:1536
    ds_read_b64_tr_b16 v[104:105], v212 offset:128
    v_mfma_f32_16x16x32_bf16 v[84:87], v[144:147], v[156:159], v[84:87]
    ds_read_b64_tr_b16 v[106:107], v212 offset:1664
    ds_read_b64_tr_b16 v[108:109], v213 offset:128
    ds_read_b64_tr_b16 v[110:111], v213 offset:1664
    s_waitcnt lgkmcnt(0)
    v_mfma_f32_16x16x32_bf16 v[16:19], v[88:91], v[112:115], v[16:19]
    ds_read_b128 v[148:151], v217 offset:0
    v_mfma_f32_16x16x32_bf16 v[20:23], v[88:91], v[116:119], v[20:23]
    ds_read_b64_tr_b16 v[124:125], v212 offset:12288
    v_mfma_f32_16x16x32_bf16 v[24:27], v[88:91], v[120:123], v[24:27]
    ds_read_b64_tr_b16 v[126:127], v212 offset:13824
    v_mfma_f32_16x16x32_bf16 v[28:31], v[92:95], v[112:115], v[28:31]
    ds_read_b128 v[152:155], v217 offset:2048
    v_mfma_f32_16x16x32_bf16 v[32:35], v[92:95], v[116:119], v[32:35]
    ds_read_b128 v[156:159], v217 offset:4096
    v_mfma_f32_16x16x32_bf16 v[36:39], v[92:95], v[120:123], v[36:39]
    ds_read_b64_tr_b16 v[128:129], v213 offset:12288
    v_mfma_f32_16x16x32_bf16 v[40:43], v[96:99], v[112:115], v[40:43]
    ds_read_b64_tr_b16 v[130:131], v213 offset:13824
    v_mfma_f32_16x16x32_bf16 v[44:47], v[96:99], v[116:119], v[44:47]
    ds_read_b64_tr_b16 v[132:133], v214 offset:12288
    v_mfma_f32_16x16x32_bf16 v[48:51], v[96:99], v[120:123], v[48:51]
    ds_read_b64_tr_b16 v[134:135], v214 offset:13824
    v_mfma_f32_16x16x32_bf16 v[52:55], v[100:103], v[112:115], v[52:55]
    ds_read_b64_tr_b16 v[136:137], v215 offset:12288
    v_mfma_f32_16x16x32_bf16 v[56:59], v[100:103], v[116:119], v[56:59]
    ds_read_b64_tr_b16 v[138:139], v215 offset:13824
    v_mfma_f32_16x16x32_bf16 v[60:63], v[100:103], v[120:123], v[60:63]
    ds_read_b64_tr_b16 v[140:141], v212 offset:12416
    v_mfma_f32_16x16x32_bf16 v[64:67], v[104:107], v[112:115], v[64:67]
    ds_read_b64_tr_b16 v[142:143], v212 offset:13952
    v_mfma_f32_16x16x32_bf16 v[68:71], v[104:107], v[116:119], v[68:71]
    ds_read_b64_tr_b16 v[144:145], v213 offset:12416
    v_mfma_f32_16x16x32_bf16 v[72:75], v[104:107], v[120:123], v[72:75]
    ds_read_b64_tr_b16 v[146:147], v213 offset:13952
    v_mfma_f32_16x16x32_bf16 v[76:79], v[108:111], v[112:115], v[76:79]
    v_mfma_f32_16x16x32_bf16 v[80:83], v[108:111], v[116:119], v[80:83]
    v_mfma_f32_16x16x32_bf16 v[84:87], v[108:111], v[120:123], v[84:87]
    s_waitcnt lgkmcnt(0)
    s_barrier
    v_mfma_f32_16x16x32_bf16 v[16:19], v[124:127], v[148:151], v[16:19]
    ds_read_b64 v[88:89], v218 offset:0
    v_mfma_f32_16x16x32_bf16 v[28:31], v[128:131], v[148:151], v[28:31]
    ds_read_b64 v[90:91], v219 offset:0
    v_mfma_f32_16x16x32_bf16 v[20:23], v[124:127], v[152:155], v[20:23]
    ds_read_b64 v[92:93], v218 offset:6144
    v_mfma_f32_16x16x32_bf16 v[32:35], v[128:131], v[152:155], v[32:35]
    ds_read_b64 v[94:95], v219 offset:6144
    v_mfma_f32_16x16x32_bf16 v[24:27], v[124:127], v[156:159], v[24:27]
    v_mfma_f32_16x16x32_bf16 v[36:39], v[128:131], v[156:159], v[36:39]
    ds_read_b64 v[96:97], v218 offset:12288
    v_cvt_pk_bf16_f32 v160, v16, v17
    v_cvt_pk_bf16_f32 v161, v18, v19
    v_mfma_f32_16x16x32_bf16 v[40:43], v[132:135], v[148:151], v[40:43]
    ds_read_b64 v[98:99], v219 offset:12288
    v_cvt_pk_bf16_f32 v162, v28, v29
    v_cvt_pk_bf16_f32 v163, v30, v31
    v_mfma_f32_16x16x32_bf16 v[52:55], v[136:139], v[148:151], v[52:55]
    ds_write_b64 v238, v[160:161] offset:0
    ds_write_b64 v238, v[162:163] offset:8
    v_mfma_f32_16x16x32_bf16 v[44:47], v[132:135], v[152:155], v[44:47]
    ds_read_b64 v[100:101], v220 offset:0
    v_cvt_pk_bf16_f32 v164, v20, v21
    v_cvt_pk_bf16_f32 v165, v22, v23
    v_mfma_f32_16x16x32_bf16 v[56:59], v[136:139], v[152:155], v[56:59]
    ds_read_b64 v[102:103], v221 offset:0
    v_cvt_pk_bf16_f32 v166, v32, v33
    v_cvt_pk_bf16_f32 v167, v34, v35
    v_mfma_f32_16x16x32_bf16 v[48:51], v[132:135], v[156:159], v[48:51]
    ds_write_b64 v238, v[164:165] offset:1024
    ds_write_b64 v238, v[166:167] offset:1032
    v_mfma_f32_16x16x32_bf16 v[60:63], v[136:139], v[156:159], v[60:63]
    ds_read_b64 v[104:105], v220 offset:6144
    v_cvt_pk_bf16_f32 v168, v24, v25
    v_cvt_pk_bf16_f32 v169, v26, v27
    v_mfma_f32_16x16x32_bf16 v[64:67], v[140:143], v[148:151], v[64:67]
    ds_read_b64 v[106:107], v221 offset:6144
    v_cvt_pk_bf16_f32 v170, v36, v37
    v_cvt_pk_bf16_f32 v171, v38, v39
    v_mfma_f32_16x16x32_bf16 v[76:79], v[144:147], v[148:151], v[76:79]
    ds_write_b64 v238, v[168:169] offset:2048
    ds_write_b64 v238, v[170:171] offset:2056
    v_mfma_f32_16x16x32_bf16 v[68:71], v[140:143], v[152:155], v[68:71]
    ds_read_b64 v[108:109], v220 offset:12288
    v_cvt_pk_bf16_f32 v172, v40, v41
    v_cvt_pk_bf16_f32 v173, v42, v43
    v_mfma_f32_16x16x32_bf16 v[80:83], v[144:147], v[152:155], v[80:83]
    ds_read_b64 v[110:111], v221 offset:12288
    v_cvt_pk_bf16_f32 v174, v52, v53
    v_cvt_pk_bf16_f32 v175, v54, v55
    v_mfma_f32_16x16x32_bf16 v[72:75], v[140:143], v[156:159], v[72:75]
    ds_write_b64 v238, v[172:173] offset:3072
    ds_write_b64 v238, v[174:175] offset:3080
    v_mfma_f32_16x16x32_bf16 v[84:87], v[144:147], v[156:159], v[84:87]
    ds_read_b64 v[112:113], v222 offset:0
    v_cvt_pk_bf16_f32 v176, v44, v45
    v_cvt_pk_bf16_f32 v177, v46, v47
    s_waitcnt lgkmcnt(4)
    v_mfma_f32_16x16x32_bf16 v[16:19], v[88:91], v[160:163], 0
    ds_read_b64 v[114:115], v223 offset:0
    v_cvt_pk_bf16_f32 v178, v56, v57
    v_cvt_pk_bf16_f32 v179, v58, v59
    v_mfma_f32_16x16x32_bf16 v[20:23], v[88:91], v[164:167], 0
    ds_write_b64 v238, v[176:177] offset:4096
    ds_write_b64 v238, v[178:179] offset:4104
    v_mfma_f32_16x16x32_bf16 v[24:27], v[88:91], v[168:171], 0
    ds_read_b64 v[116:117], v222 offset:6144
    v_cvt_pk_bf16_f32 v180, v48, v49
    v_cvt_pk_bf16_f32 v181, v50, v51
    v_mfma_f32_16x16x32_bf16 v[28:31], v[92:95], v[160:163], 0
    ds_read_b64 v[118:119], v223 offset:6144
    v_cvt_pk_bf16_f32 v182, v60, v61
    v_cvt_pk_bf16_f32 v183, v62, v63
    v_mfma_f32_16x16x32_bf16 v[32:35], v[92:95], v[164:167], 0
    ds_write_b64 v238, v[180:181] offset:5120
    ds_write_b64 v238, v[182:183] offset:5128
    v_mfma_f32_16x16x32_bf16 v[36:39], v[92:95], v[168:171], 0
    ds_read_b64 v[120:121], v222 offset:12288
    v_cvt_pk_bf16_f32 v184, v64, v65
    v_cvt_pk_bf16_f32 v185, v66, v67
    v_mfma_f32_16x16x32_bf16 v[40:43], v[96:99], v[160:163], 0
    ds_read_b64 v[122:123], v223 offset:12288
    v_cvt_pk_bf16_f32 v186, v76, v77
    v_cvt_pk_bf16_f32 v187, v78, v79
    v_mfma_f32_16x16x32_bf16 v[44:47], v[96:99], v[164:167], 0
    ds_write_b64 v238, v[184:185] offset:6144
    ds_write_b64 v238, v[186:187] offset:6152
    v_mfma_f32_16x16x32_bf16 v[48:51], v[96:99], v[168:171], 0
    v_cvt_pk_bf16_f32 v188, v68, v69
    v_cvt_pk_bf16_f32 v189, v70, v71
    s_waitcnt lgkmcnt(2)
    v_mfma_f32_16x16x32_bf16 v[16:19], v[100:103], v[172:175], v[16:19]
    v_cvt_pk_bf16_f32 v190, v80, v81
    v_cvt_pk_bf16_f32 v191, v82, v83
    v_mfma_f32_16x16x32_bf16 v[20:23], v[100:103], v[176:179], v[20:23]
    ds_write_b64 v238, v[188:189] offset:7168
    ds_write_b64 v238, v[190:191] offset:7176
    v_mfma_f32_16x16x32_bf16 v[24:27], v[100:103], v[180:183], v[24:27]
    v_cvt_pk_bf16_f32 v192, v72, v73
    v_cvt_pk_bf16_f32 v193, v74, v75
    v_mfma_f32_16x16x32_bf16 v[28:31], v[104:107], v[172:175], v[28:31]
    v_cvt_pk_bf16_f32 v194, v84, v85
    v_cvt_pk_bf16_f32 v195, v86, v87
    v_mfma_f32_16x16x32_bf16 v[32:35], v[104:107], v[176:179], v[32:35]
    ds_write_b64 v238, v[192:193] offset:8192
    ds_write_b64 v238, v[194:195] offset:8200
    v_mfma_f32_16x16x32_bf16 v[36:39], v[104:107], v[180:183], v[36:39]
    v_mfma_f32_16x16x32_bf16 v[40:43], v[108:111], v[172:175], v[40:43]
    v_mfma_f32_16x16x32_bf16 v[44:47], v[108:111], v[176:179], v[44:47]
    v_mfma_f32_16x16x32_bf16 v[48:51], v[108:111], v[180:183], v[48:51]
    s_waitcnt lgkmcnt(0)
    s_barrier
    ds_read_b128 v[124:127], v239 offset:0
    v_mfma_f32_16x16x32_bf16 v[16:19], v[112:115], v[184:187], v[16:19]
    ds_read_b128 v[128:131], v239 offset:1024
    v_mfma_f32_16x16x32_bf16 v[20:23], v[112:115], v[188:191], v[20:23]
    ds_read_b128 v[132:135], v239 offset:2048
    v_mfma_f32_16x16x32_bf16 v[24:27], v[112:115], v[192:195], v[24:27]
    ds_read_b64 v[88:89], v224 offset:0
    ds_read_b64 v[90:91], v225 offset:0
    v_mfma_f32_16x16x32_bf16 v[28:31], v[116:119], v[184:187], v[28:31]
    ds_read_b64 v[92:93], v224 offset:6144
    ds_read_b64 v[94:95], v225 offset:6144
    v_mfma_f32_16x16x32_bf16 v[32:35], v[116:119], v[188:191], v[32:35]
    ds_read_b64 v[96:97], v224 offset:12288
    ds_read_b64 v[98:99], v225 offset:12288
    v_mfma_f32_16x16x32_bf16 v[36:39], v[116:119], v[192:195], v[36:39]
    ds_read_b128 v[136:139], v239 offset:3072
    v_mfma_f32_16x16x32_bf16 v[40:43], v[120:123], v[184:187], v[40:43]
    ds_read_b128 v[140:143], v239 offset:4096
    v_mfma_f32_16x16x32_bf16 v[44:47], v[120:123], v[188:191], v[44:47]
    ds_read_b128 v[144:147], v239 offset:5120
    v_mfma_f32_16x16x32_bf16 v[48:51], v[120:123], v[192:195], v[48:51]
    s_waitcnt lgkmcnt(3)
    ds_read_b64 v[100:101], v226 offset:0
    ds_read_b64 v[102:103], v227 offset:0
    v_mfma_f32_16x16x32_bf16 v[16:19], v[88:91], v[124:127], v[16:19]
    ds_read_b64 v[104:105], v226 offset:6144
    ds_read_b64 v[106:107], v227 offset:6144
    v_mfma_f32_16x16x32_bf16 v[20:23], v[88:91], v[128:131], v[20:23]
    ds_read_b64 v[108:109], v226 offset:12288
    ds_read_b64 v[110:111], v227 offset:12288
    v_mfma_f32_16x16x32_bf16 v[24:27], v[88:91], v[132:135], v[24:27]
    ds_read_b128 v[148:151], v239 offset:6144
    v_mfma_f32_16x16x32_bf16 v[28:31], v[92:95], v[124:127], v[28:31]
    ds_read_b128 v[152:155], v239 offset:7168
    v_mfma_f32_16x16x32_bf16 v[32:35], v[92:95], v[128:131], v[32:35]
    ds_read_b128 v[156:159], v239 offset:8192
    v_mfma_f32_16x16x32_bf16 v[36:39], v[92:95], v[132:135], v[36:39]
    ds_read_b64 v[112:113], v228 offset:0
    ds_read_b64 v[114:115], v229 offset:0
    v_mfma_f32_16x16x32_bf16 v[40:43], v[96:99], v[124:127], v[40:43]
    ds_read_b64 v[116:117], v228 offset:6144
    ds_read_b64 v[118:119], v229 offset:6144
    v_mfma_f32_16x16x32_bf16 v[44:47], v[96:99], v[128:131], v[44:47]
    ds_read_b64 v[120:121], v228 offset:12288
    ds_read_b64 v[122:123], v229 offset:12288
    v_mfma_f32_16x16x32_bf16 v[48:51], v[96:99], v[132:135], v[48:51]
    s_waitcnt lgkmcnt(9)
    v_mfma_f32_16x16x32_bf16 v[16:19], v[100:103], v[136:139], v[16:19]
    v_mfma_f32_16x16x32_bf16 v[28:31], v[104:107], v[136:139], v[28:31]
    v_mfma_f32_16x16x32_bf16 v[40:43], v[108:111], v[136:139], v[40:43]
    s_waitcnt lgkmcnt(0)
    v_mfma_f32_16x16x32_bf16 v[16:19], v[112:115], v[148:151], v[16:19]
    v_mfma_f32_16x16x32_bf16 v[28:31], v[116:119], v[148:151], v[28:31]
    v_mfma_f32_16x16x32_bf16 v[40:43], v[120:123], v[148:151], v[40:43]
    v_mfma_f32_16x16x32_bf16 v[20:23], v[100:103], v[140:143], v[20:23]
    v_mfma_f32_16x16x32_bf16 v[32:35], v[104:107], v[140:143], v[32:35]
    v_mfma_f32_16x16x32_bf16 v[44:47], v[108:111], v[140:143], v[44:47]
    v_mfma_f32_16x16x32_bf16 v[20:23], v[112:115], v[152:155], v[20:23]
    v_mfma_f32_16x16x32_bf16 v[32:35], v[116:119], v[152:155], v[32:35]
    v_mfma_f32_16x16x32_bf16 v[44:47], v[120:123], v[152:155], v[44:47]
    v_max3_f32 v8, v16, v17, v18
    v_max3_f32 v8, v8, v19, v28
    v_mfma_f32_16x16x32_bf16 v[24:27], v[100:103], v[144:147], v[24:27]
    v_max3_f32 v8, v8, v29, v30
    v_max3_f32 v8, v8, v31, v40
    v_mfma_f32_16x16x32_bf16 v[36:39], v[104:107], v[144:147], v[36:39]
    v_max3_f32 v8, v8, v41, v42
    v_max_f32 v8, v8, v43
    v_mfma_f32_16x16x32_bf16 v[48:51], v[108:111], v[144:147], v[48:51]
    v_mfma_f32_16x16x32_bf16 v[24:27], v[112:115], v[156:159], v[24:27]
    v_mfma_f32_16x16x32_bf16 v[36:39], v[116:119], v[156:159], v[36:39]
    v_mfma_f32_16x16x32_bf16 v[48:51], v[120:123], v[156:159], v[48:51]
    v_max3_f32 v9, v20, v21, v22
    v_max3_f32 v9, v9, v23, v32
    v_max3_f32 v9, v9, v33, v34
    v_max3_f32 v9, v9, v35, v44
    v_max3_f32 v9, v9, v45, v46
    v_max_f32 v9, v9, v47
    s_nop 1
    v_max3_f32 v10, v24, v25, v26
    v_max3_f32 v10, v10, v27, v36
    v_max3_f32 v10, v10, v37, v38
    v_max3_f32 v10, v10, v39, v48
    v_max3_f32 v10, v10, v49, v50
    v_max_f32 v10, v10, v51
    v_mov_b32 v11, v8
    v_mov_b32 v12, v9
    v_mov_b32 v13, v10
    v_permlane16_swap_b32 v11, v8
    v_permlane16_swap_b32 v12, v9
    v_permlane16_swap_b32 v13, v10
    v_max_f32 v8, v8, v11
    v_max_f32 v9, v9, v12
    v_max_f32 v10, v10, v13
    v_mov_b32 v11, v8
    v_mov_b32 v12, v9
    v_mov_b32 v13, v10
    v_permlane32_swap_b32 v11, v8
    v_permlane32_swap_b32 v12, v9
    v_permlane32_swap_b32 v13, v10
    v_max_f32 v8, v8, v11
    v_max_f32 v9, v9, v12
    v_max_f32 v10, v10, v13
    ds_write_b32 v240, v8 offset:0
    ds_write_b32 v240, v9 offset:64
    ds_write_b32 v240, v10 offset:128
    s_waitcnt lgkmcnt(0)
    s_barrier
    ds_read_b32 v11, v241 offset:0
    ds_read_b32 v12, v241 offset:64
    ds_read_b32 v13, v241 offset:128
    ds_read_b64_tr_b16 v[160:161], v230 offset:0
    ds_read_b64_tr_b16 v[162:163], v230 offset:6144
    ds_read_b64_tr_b16 v[164:165], v231 offset:0
    ds_read_b64_tr_b16 v[166:167], v231 offset:6144
    ds_read_b64_tr_b16 v[168:169], v232 offset:0
    ds_read_b64_tr_b16 v[170:171], v232 offset:6144
    ds_read_b64_tr_b16 v[172:173], v233 offset:0
    ds_read_b64_tr_b16 v[174:175], v233 offset:6144
    ds_read_b64_tr_b16 v[176:177], v230 offset:128
    ds_read_b64_tr_b16 v[178:179], v230 offset:6272
    ds_read_b64_tr_b16 v[180:181], v231 offset:128
    ds_read_b64_tr_b16 v[182:183], v231 offset:6272
    ds_read_b64_tr_b16 v[124:125], v230 offset:12288
    ds_read_b64_tr_b16 v[126:127], v234 offset:12288
    ds_read_b64_tr_b16 v[128:129], v231 offset:12288
    ds_read_b64_tr_b16 v[130:131], v235 offset:12288
    ds_read_b64_tr_b16 v[132:133], v232 offset:12288
    ds_read_b64_tr_b16 v[134:135], v236 offset:12288
    ds_read_b64_tr_b16 v[136:137], v233 offset:12288
    ds_read_b64_tr_b16 v[138:139], v237 offset:12288
    ds_read_b64_tr_b16 v[140:141], v230 offset:12416
    ds_read_b64_tr_b16 v[142:143], v234 offset:12416
    ds_read_b64_tr_b16 v[144:145], v231 offset:12416
    ds_read_b64_tr_b16 v[146:147], v235 offset:12416
    s_waitcnt lgkmcnt(15)
    ds_read_b64 v[254:255], v247
    v_max_f32 v8, v8, v11
    v_max_f32 v9, v9, v12
    v_max_f32 v10, v10, v13
    v_mul_f32 v2, s52, v8
    v_mul_f32 v4, s52, v9
    v_mul_f32 v6, s52, v10
    v_mov_b32 v3, v2
    v_mov_b32 v5, v4
    v_mov_b32 v7, v6
    v_pk_fma_f32 v[16:17], v[16:17], s[52:53], v[2:3] neg_lo:[0,0,1] neg_hi:[0,0,1]
    v_pk_fma_f32 v[18:19], v[18:19], s[52:53], v[2:3] neg_lo:[0,0,1] neg_hi:[0,0,1]
    v_exp_f32 v16, v16
    v_pk_fma_f32 v[28:29], v[28:29], s[52:53], v[2:3] neg_lo:[0,0,1] neg_hi:[0,0,1]
    v_exp_f32 v17, v17
    v_exp_f32 v18, v18
    v_pk_fma_f32 v[30:31], v[30:31], s[52:53], v[2:3] neg_lo:[0,0,1] neg_hi:[0,0,1]
    v_exp_f32 v19, v19
    v_cvt_pk_bf16_f32 v88, v16, v17
    v_exp_f32 v28, v28
    v_pk_fma_f32 v[40:41], v[40:41], s[52:53], v[2:3] neg_lo:[0,0,1] neg_hi:[0,0,1]
    v_exp_f32 v29, v29
    v_cvt_pk_bf16_f32 v89, v18, v19
    v_exp_f32 v30, v30
    v_pk_fma_f32 v[42:43], v[42:43], s[52:53], v[2:3] neg_lo:[0,0,1] neg_hi:[0,0,1]
    v_exp_f32 v31, v31
    v_cvt_pk_bf16_f32 v90, v28, v29
    v_exp_f32 v40, v40
    v_exp_f32 v41, v41
    v_cvt_pk_bf16_f32 v91, v30, v31
    v_exp_f32 v42, v42
    v_exp_f32 v43, v43
    v_cvt_pk_bf16_f32 v92, v40, v41
    s_nop 0
    v_cvt_pk_bf16_f32 v93, v42, v43
    ds_write_b128 v242, v[88:91] offset:0
    ds_write_b64 v244, v[92:93] offset:1024
    s_waitcnt lgkmcnt(2)
    v_fma_f32 v20, v20, s52, -v4
    v_fma_f32 v21, v21, s52, -v4
    v_fma_f32 v22, v22, s52, -v4
    v_mfma_f32_16x16x32_bf16 v[52:55], v[160:163], v[88:91], 0
    v_fma_f32 v23, v23, s52, -v4
    v_exp_f32 v20, v20
    v_fma_f32 v32, v32, s52, -v4
    v_exp_f32 v21, v21
    v_fma_f32 v33, v33, s52, -v4
    v_mfma_f32_16x16x32_bf16 v[56:59], v[164:167], v[88:91], 0
    v_exp_f32 v22, v22
    v_fma_f32 v34, v34, s52, -v4
    v_exp_f32 v23, v23
    v_fma_f32 v35, v35, s52, -v4
    v_cvt_pk_bf16_f32 v96, v20, v21
    v_mfma_f32_16x16x32_bf16 v[60:63], v[168:171], v[88:91], 0
    v_exp_f32 v32, v32
    v_fma_f32 v44, v44, s52, -v4
    v_exp_f32 v33, v33
    v_fma_f32 v45, v45, s52, -v4
    v_cvt_pk_bf16_f32 v97, v22, v23
    v_mfma_f32_16x16x32_bf16 v[16:19], v[172:175], v[88:91], 0
    v_exp_f32 v34, v34
    v_fma_f32 v46, v46, s52, -v4
    v_exp_f32 v35, v35
    v_fma_f32 v47, v47, s52, -v4
    v_cvt_pk_bf16_f32 v98, v32, v33
    v_mfma_f32_16x16x32_bf16 v[28:31], v[176:179], v[88:91], 0
    v_exp_f32 v44, v44
    v_exp_f32 v45, v45
    v_cvt_pk_bf16_f32 v99, v34, v35
    v_exp_f32 v46, v46
    v_exp_f32 v47, v47
    v_mfma_f32_16x16x32_bf16 v[40:43], v[180:183], v[88:91], 0
    v_cvt_pk_bf16_f32 v100, v44, v45
    s_nop 0
    v_cvt_pk_bf16_f32 v101, v46, v47
    v_mfma_f32_16x16x32_bf16 v[196:199], v[208:211], v[88:91], 0
    ds_write_b128 v242, v[96:99] offset:1536
    ds_write_b64 v244, v[100:101] offset:2560
    v_fma_f32 v24, v24, s52, -v6
    v_fma_f32 v25, v25, s52, -v6
    v_fma_f32 v26, v26, s52, -v6
    v_mfma_f32_16x16x32_bf16 v[64:67], v[160:163], v[96:99], 0
    v_fma_f32 v27, v27, s52, -v6
    v_exp_f32 v24, v24
    v_fma_f32 v36, v36, s52, -v6
    v_exp_f32 v25, v25
    v_fma_f32 v37, v37, s52, -v6
    v_mfma_f32_16x16x32_bf16 v[68:71], v[164:167], v[96:99], 0
    v_exp_f32 v26, v26
    v_fma_f32 v38, v38, s52, -v6
    v_exp_f32 v27, v27
    v_fma_f32 v39, v39, s52, -v6
    v_cvt_pk_bf16_f32 v104, v24, v25
    v_mfma_f32_16x16x32_bf16 v[72:75], v[168:171], v[96:99], 0
    v_exp_f32 v36, v36
    v_fma_f32 v48, v48, s52, -v6
    v_exp_f32 v37, v37
    v_fma_f32 v49, v49, s52, -v6
    v_cvt_pk_bf16_f32 v105, v26, v27
    v_mfma_f32_16x16x32_bf16 v[20:23], v[172:175], v[96:99], 0
    v_exp_f32 v38, v38
    v_fma_f32 v50, v50, s52, -v6
    v_exp_f32 v39, v39
    v_fma_f32 v51, v51, s52, -v6
    v_cvt_pk_bf16_f32 v106, v36, v37
    v_mfma_f32_16x16x32_bf16 v[32:35], v[176:179], v[96:99], 0
    v_exp_f32 v48, v48
    v_exp_f32 v49, v49
    v_cvt_pk_bf16_f32 v107, v38, v39
    v_exp_f32 v50, v50
    v_exp_f32 v51, v51
    v_mfma_f32_16x16x32_bf16 v[44:47], v[180:183], v[96:99], 0
    v_cvt_pk_bf16_f32 v108, v48, v49
    s_nop 0
    v_cvt_pk_bf16_f32 v109, v50, v51
    v_mfma_f32_16x16x32_bf16 v[200:203], v[208:211], v[96:99], 0
    ds_write_b128 v242, v[104:107] offset:3072
    ds_write_b64 v244, v[108:109] offset:4096
    s_waitcnt lgkmcnt(0)
    s_barrier
    ds_read_b64 v[94:95], v245 offset:1024
    v_mfma_f32_16x16x32_bf16 v[76:79], v[160:163], v[104:107], 0
    ds_read_b64 v[102:103], v245 offset:2560
    v_mfma_f32_16x16x32_bf16 v[80:83], v[164:167], v[104:107], 0
    ds_read_b64 v[110:111], v245 offset:4096
    v_mfma_f32_16x16x32_bf16 v[84:87], v[168:171], v[104:107], 0
    ds_read_b128 v[112:115], v243 offset:0
    v_mfma_f32_16x16x32_bf16 v[24:27], v[172:175], v[104:107], 0
    ds_read_b128 v[116:119], v243 offset:1536
    v_mfma_f32_16x16x32_bf16 v[36:39], v[176:179], v[104:107], 0
    ds_read_b128 v[120:123], v243 offset:3072
    v_mfma_f32_16x16x32_bf16 v[48:51], v[180:183], v[104:107], 0
    ds_read_b64_tr_b16 v[148:149], v234 offset:0
    v_mfma_f32_16x16x32_bf16 v[204:207], v[208:211], v[104:107], 0
    ds_read_b64_tr_b16 v[150:151], v234 offset:6144
    s_waitcnt lgkmcnt(5)
    v_mfma_f32_16x16x32_bf16 v[52:55], v[124:127], v[92:95], v[52:55]
    ds_read_b64_tr_b16 v[152:153], v235 offset:0
    v_mfma_f32_16x16x32_bf16 v[56:59], v[128:131], v[92:95], v[56:59]
    ds_read_b64_tr_b16 v[154:155], v235 offset:6144
    v_mfma_f32_16x16x32_bf16 v[60:63], v[132:135], v[92:95], v[60:63]
    ds_read_b64_tr_b16 v[156:157], v236 offset:0
    v_mfma_f32_16x16x32_bf16 v[16:19], v[136:139], v[92:95], v[16:19]
    ds_read_b64_tr_b16 v[158:159], v236 offset:6144
    v_mfma_f32_16x16x32_bf16 v[28:31], v[140:143], v[92:95], v[28:31]
    ds_read_b64_tr_b16 v[184:185], v237 offset:0
    v_mfma_f32_16x16x32_bf16 v[40:43], v[144:147], v[92:95], v[40:43]
    ds_read_b64_tr_b16 v[186:187], v237 offset:6144
    v_mfma_f32_16x16x32_bf16 v[196:199], v[208:211], v[92:95], v[196:199]
    ds_read_b64_tr_b16 v[188:189], v234 offset:128
    v_mfma_f32_16x16x32_bf16 v[64:67], v[124:127], v[100:103], v[64:67]
    ds_read_b64_tr_b16 v[190:191], v234 offset:6272
    v_mfma_f32_16x16x32_bf16 v[68:71], v[128:131], v[100:103], v[68:71]
    ds_read_b64_tr_b16 v[192:193], v235 offset:128
    v_mfma_f32_16x16x32_bf16 v[72:75], v[132:135], v[100:103], v[72:75]
    ds_read_b64_tr_b16 v[194:195], v235 offset:6272
    v_mfma_f32_16x16x32_bf16 v[20:23], v[136:139], v[100:103], v[20:23]
    v_mfma_f32_16x16x32_bf16 v[32:35], v[140:143], v[100:103], v[32:35]
    v_mfma_f32_16x16x32_bf16 v[44:47], v[144:147], v[100:103], v[44:47]
    v_mfma_f32_16x16x32_bf16 v[200:203], v[208:211], v[100:103], v[200:203]
    s_waitcnt lgkmcnt(0)
    v_mfma_f32_16x16x32_bf16 v[196:199], v[208:211], v[112:115], v[196:199]
    v_mfma_f32_16x16x32_bf16 v[52:55], v[148:151], v[112:115], v[52:55]
    v_mfma_f32_16x16x32_bf16 v[56:59], v[152:155], v[112:115], v[56:59]
    v_mfma_f32_16x16x32_bf16 v[60:63], v[156:159], v[112:115], v[60:63]
    v_mfma_f32_16x16x32_bf16 v[16:19], v[184:187], v[112:115], v[16:19]
    v_mfma_f32_16x16x32_bf16 v[28:31], v[188:191], v[112:115], v[28:31]
    v_mfma_f32_16x16x32_bf16 v[40:43], v[192:195], v[112:115], v[40:43]
    v_mfma_f32_16x16x32_bf16 v[76:79], v[124:127], v[108:111], v[76:79]
    v_mfma_f32_16x16x32_bf16 v[80:83], v[128:131], v[108:111], v[80:83]
    v_rcp_f32 v8, v196
    s_nop 0
    v_mfma_f32_16x16x32_bf16 v[84:87], v[132:135], v[108:111], v[84:87]
    v_mov_b32 v9, v8
    v_mul_f32 v52, v8, v52
    v_mfma_f32_16x16x32_bf16 v[24:27], v[136:139], v[108:111], v[24:27]
    v_mul_f32 v53, v8, v53
    v_mul_f32 v54, v8, v54
    v_mfma_f32_16x16x32_bf16 v[36:39], v[140:143], v[108:111], v[36:39]
    v_mul_f32 v55, v8, v55
    v_mul_f32 v56, v8, v56
    v_mfma_f32_16x16x32_bf16 v[48:51], v[144:147], v[108:111], v[48:51]
    v_mul_f32 v57, v8, v57
    v_mul_f32 v58, v8, v58
    v_mfma_f32_16x16x32_bf16 v[204:207], v[208:211], v[108:111], v[204:207]
    v_mul_f32 v59, v8, v59
    v_cvt_pk_bf16_f32 v160, v52, v53
    v_mfma_f32_16x16x32_bf16 v[200:203], v[208:211], v[116:119], v[200:203]
    v_cvt_pk_bf16_f32 v161, v54, v55
    v_cvt_pk_bf16_f32 v162, v56, v57
    v_mfma_f32_16x16x32_bf16 v[64:67], v[148:151], v[116:119], v[64:67]
    v_cvt_pk_bf16_f32 v163, v58, v59
    v_mfma_f32_16x16x32_bf16 v[68:71], v[152:155], v[116:119], v[68:71]
    s_mov_b32 s3, 0
    buffer_store_dwordx4 v[160:163], v246, s[8:11], s3 offen sc1
    v_mfma_f32_16x16x32_bf16 v[72:75], v[156:159], v[116:119], v[72:75]
    v_mul_f32 v60, v8, v60
    v_mul_f32 v61, v8, v61
    v_mfma_f32_16x16x32_bf16 v[20:23], v[184:187], v[116:119], v[20:23]
    v_mul_f32 v62, v8, v62
    v_mul_f32 v63, v8, v63
    v_mfma_f32_16x16x32_bf16 v[32:35], v[188:191], v[116:119], v[32:35]
    v_mul_f32 v16, v8, v16
    v_mul_f32 v17, v8, v17
    v_mfma_f32_16x16x32_bf16 v[44:47], v[192:195], v[116:119], v[44:47]
    v_mul_f32 v18, v8, v18
    v_mul_f32 v19, v8, v19
    v_cvt_pk_bf16_f32 v172, v60, v61
    v_cvt_pk_bf16_f32 v173, v62, v63
    v_cvt_pk_bf16_f32 v174, v16, v17
    v_cvt_pk_bf16_f32 v175, v18, v19
    s_mov_b32 s3, 6144
    buffer_store_dwordx4 v[172:175], v246, s[8:11], s3 offen sc1
    v_mul_f32 v28, v8, v28
    v_mul_f32 v29, v8, v29
    v_mul_f32 v30, v8, v30
    v_mul_f32 v31, v8, v31
    v_mul_f32 v40, v8, v40
    v_mul_f32 v41, v8, v41
    v_mul_f32 v42, v8, v42
    v_mul_f32 v43, v8, v43
    v_cvt_pk_bf16_f32 v212, v28, v29
    v_cvt_pk_bf16_f32 v213, v30, v31
    v_cvt_pk_bf16_f32 v214, v40, v41
    v_cvt_pk_bf16_f32 v215, v42, v43
    s_mov_b32 s3, 12288
    buffer_store_dwordx4 v[212:215], v246, s[8:11], s3 offen sc1
    v_mfma_f32_16x16x32_bf16 v[204:207], v[208:211], v[120:123], v[204:207]
    v_rcp_f32 v10, v200
    s_nop 0
    v_mfma_f32_16x16x32_bf16 v[76:79], v[148:151], v[120:123], v[76:79]
    v_mov_b32 v11, v10
    v_mul_f32 v64, v10, v64
    v_mfma_f32_16x16x32_bf16 v[80:83], v[152:155], v[120:123], v[80:83]
    v_mul_f32 v65, v10, v65
    v_mul_f32 v66, v10, v66
    v_mfma_f32_16x16x32_bf16 v[84:87], v[156:159], v[120:123], v[84:87]
    v_mul_f32 v67, v10, v67
    v_mul_f32 v68, v10, v68
    v_mfma_f32_16x16x32_bf16 v[24:27], v[184:187], v[120:123], v[24:27]
    v_mul_f32 v69, v10, v69
    v_mul_f32 v70, v10, v70
    v_mfma_f32_16x16x32_bf16 v[36:39], v[188:191], v[120:123], v[36:39]
    v_mul_f32 v71, v10, v71
    v_cvt_pk_bf16_f32 v164, v64, v65
    v_mfma_f32_16x16x32_bf16 v[48:51], v[192:195], v[120:123], v[48:51]
    v_cvt_pk_bf16_f32 v165, v66, v67
    v_cvt_pk_bf16_f32 v166, v68, v69
    v_cvt_pk_bf16_f32 v167, v70, v71
    s_mov_b32 s3, 1024
    buffer_store_dwordx4 v[164:167], v246, s[8:11], s3 offen sc1
    v_mul_f32 v72, v10, v72
    v_mul_f32 v73, v10, v73
    v_mul_f32 v74, v10, v74
    v_mul_f32 v75, v10, v75
    v_mul_f32 v20, v10, v20
    v_mul_f32 v21, v10, v21
    v_mul_f32 v22, v10, v22
    v_mul_f32 v23, v10, v23
    v_cvt_pk_bf16_f32 v176, v72, v73
    v_cvt_pk_bf16_f32 v177, v74, v75
    v_cvt_pk_bf16_f32 v178, v20, v21
    v_cvt_pk_bf16_f32 v179, v22, v23
    s_mov_b32 s3, 7168
    buffer_store_dwordx4 v[176:179], v246, s[8:11], s3 offen sc1
    v_mul_f32 v32, v10, v32
    v_mul_f32 v33, v10, v33
    v_mul_f32 v34, v10, v34
    v_mul_f32 v35, v10, v35
    v_mul_f32 v44, v10, v44
    v_mul_f32 v45, v10, v45
    v_mul_f32 v46, v10, v46
    v_mul_f32 v47, v10, v47
    v_cvt_pk_bf16_f32 v216, v32, v33
    v_cvt_pk_bf16_f32 v217, v34, v35
    v_cvt_pk_bf16_f32 v218, v44, v45
    v_cvt_pk_bf16_f32 v219, v46, v47
    s_mov_b32 s3, 13312
    buffer_store_dwordx4 v[216:219], v246, s[8:11], s3 offen sc1
    v_rcp_f32 v12, v204
    s_nop 0
    v_mov_b32 v13, v12
    v_pk_mul_f32 v[76:77], v[76:77], v[12:13]
    v_pk_mul_f32 v[78:79], v[78:79], v[12:13]
    v_pk_mul_f32 v[80:81], v[80:81], v[12:13]
    v_pk_mul_f32 v[82:83], v[82:83], v[12:13]
    v_cvt_pk_bf16_f32 v168, v76, v77
    v_cvt_pk_bf16_f32 v169, v78, v79
    v_cvt_pk_bf16_f32 v170, v80, v81
    v_cvt_pk_bf16_f32 v171, v82, v83
    s_mov_b32 s3, 2048
    buffer_store_dwordx4 v[168:171], v246, s[8:11], s3 offen sc1
    v_pk_mul_f32 v[84:85], v[84:85], v[12:13]
    v_pk_mul_f32 v[86:87], v[86:87], v[12:13]
    v_pk_mul_f32 v[24:25], v[24:25], v[12:13]
    v_pk_mul_f32 v[26:27], v[26:27], v[12:13]
    v_cvt_pk_bf16_f32 v180, v84, v85
    v_cvt_pk_bf16_f32 v181, v86, v87
    v_cvt_pk_bf16_f32 v182, v24, v25
    v_cvt_pk_bf16_f32 v183, v26, v27
    s_mov_b32 s3, 8192
    buffer_store_dwordx4 v[180:183], v246, s[8:11], s3 offen sc1
    v_pk_mul_f32 v[36:37], v[36:37], v[12:13]
    v_pk_mul_f32 v[38:39], v[38:39], v[12:13]
    v_pk_mul_f32 v[48:49], v[48:49], v[12:13]
    v_pk_mul_f32 v[50:51], v[50:51], v[12:13]
    v_cvt_pk_bf16_f32 v220, v36, v37
    v_cvt_pk_bf16_f32 v221, v38, v39
    v_cvt_pk_bf16_f32 v222, v48, v49
    v_cvt_pk_bf16_f32 v223, v50, v51
    s_mov_b32 s3, 14336
    buffer_store_dwordx4 v[220:223], v246, s[8:11], s3 offen sc1
    s_waitcnt lgkmcnt(0)
    s_barrier
    ds_write_b128 v246, v[160:163] offset:0
    ds_write_b128 v246, v[172:175] offset:6144
    ds_write_b128 v246, v[212:215] offset:12288
    ds_write_b128 v246, v[164:167] offset:1024
    ds_write_b128 v246, v[176:179] offset:7168
    ds_write_b128 v246, v[216:219] offset:13312
    ds_write_b128 v246, v[168:171] offset:2048
    ds_write_b128 v246, v[180:183] offset:8192
    ds_write_b128 v246, v[220:223] offset:14336
    v_mov_b32 v16, 0
    v_mov_b32 v17, 0
    v_mov_b32 v18, 0
    v_mov_b32 v19, 0
    v_mov_b32 v20, 0
    v_mov_b32 v21, 0
    v_mov_b32 v22, 0
    v_mov_b32 v23, 0
    v_mov_b32 v24, 0
    v_mov_b32 v25, 0
    v_mov_b32 v26, 0
    v_mov_b32 v27, 0
    v_mov_b32 v28, 0
    v_mov_b32 v29, 0
    v_mov_b32 v30, 0
    v_mov_b32 v31, 0
    v_mov_b32 v32, 0
    v_mov_b32 v33, 0
    v_mov_b32 v34, 0
    v_mov_b32 v35, 0
    v_mov_b32 v36, 0
    v_mov_b32 v37, 0
    v_mov_b32 v38, 0
    v_mov_b32 v39, 0
    v_mov_b32 v40, 0
    v_mov_b32 v41, 0
    v_mov_b32 v42, 0
    v_mov_b32 v43, 0
    v_mov_b32 v44, 0
    v_mov_b32 v45, 0
    v_mov_b32 v46, 0
    v_mov_b32 v47, 0
    v_mov_b32 v48, 0
    v_mov_b32 v49, 0
    v_mov_b32 v50, 0
    v_mov_b32 v51, 0
    v_mov_b32 v52, 0
    v_mov_b32 v53, 0
    v_mov_b32 v54, 0
    v_mov_b32 v55, 0
    v_mov_b32 v56, 0
    v_mov_b32 v57, 0
    v_mov_b32 v58, 0
    v_mov_b32 v59, 0
    v_mov_b32 v60, 0
    v_mov_b32 v61, 0
    v_mov_b32 v62, 0
    v_mov_b32 v63, 0
    v_mov_b32 v64, 0
    v_mov_b32 v65, 0
    v_mov_b32 v66, 0
    v_mov_b32 v67, 0
    v_mov_b32 v68, 0
    v_mov_b32 v69, 0
    v_mov_b32 v70, 0
    v_mov_b32 v71, 0
    v_mov_b32 v72, 0
    v_mov_b32 v73, 0
    v_mov_b32 v74, 0
    v_mov_b32 v75, 0
    s_mov_b32 s58, 0xffff1000
    s_mov_b32 s59, 20480
    s_mov_b32 s6, 0xffff1000
    s_mov_b32 s7, 12288
    s_mov_b32 s56, 1
    s_mov_b32 s18, 0
    s_mov_b32 s55, 0
    s_waitcnt vmcnt(0)
    s_mov_b64 exec, 1
    buffer_store_dwordx2 v[254:255], v15, s[24:27], s16 offen sc1
    s_mov_b64 exec, -1
    s_waitcnt lgkmcnt(0)
    s_barrier
    ds_read_b128 v[108:111], v250 offset:0
    ds_read_b64_tr_b16 v[88:89], v248 offset:0
    ds_read_b64_tr_b16 v[90:91], v248 offset:5120
    ds_read_b128 v[112:115], v250 offset:1024
    ds_read_b128 v[116:119], v250 offset:2048
    ds_read_b64_tr_b16 v[92:93], v249 offset:0
    ds_read_b64_tr_b16 v[94:95], v249 offset:5120
    ds_read_b64_tr_b16 v[96:97], v248 offset:64
    ds_read_b64_tr_b16 v[98:99], v248 offset:5184
    ds_read_b64_tr_b16 v[100:101], v249 offset:64
    ds_read_b64_tr_b16 v[102:103], v249 offset:5184
    ds_read_b64_tr_b16 v[104:105], v248 offset:128
    ds_read_b64_tr_b16 v[106:107], v248 offset:5248
    s_waitcnt lgkmcnt(0)
L_p4:
    v_mfma_f32_16x16x32_bf16 v[16:19], v[88:91], v[108:111], v[16:19]
    ds_read_b128 v[140:143], v250 offset:6144
    s_add_u32 s56, s56, 1
    v_mfma_f32_16x16x32_bf16 v[20:23], v[88:91], v[112:115], v[20:23]
    ds_read_b64_tr_b16 v[120:121], v248 offset:10240
    s_cmp_eq_u32 s56, 4
    v_mfma_f32_16x16x32_bf16 v[24:27], v[88:91], v[116:119], v[24:27]
    ds_read_b64_tr_b16 v[122:123], v248 offset:15360
    s_cselect_b32 s54, s58, s59
    v_mfma_f32_16x16x32_bf16 v[28:31], v[92:95], v[108:111], v[28:31]
    ds_read_b128 v[144:147], v250 offset:7168
    s_cselect_b32 s56, 0, s56
    v_mfma_f32_16x16x32_bf16 v[32:35], v[92:95], v[112:115], v[32:35]
    ds_read_b128 v[148:151], v250 offset:8192
    s_add_u32 s18, s18, 1
    v_mfma_f32_16x16x32_bf16 v[36:39], v[92:95], v[116:119], v[36:39]
    ds_read_b64_tr_b16 v[124:125], v249 offset:10240
    s_cmp_eq_u32 s18, 6
    v_mfma_f32_16x16x32_bf16 v[40:43], v[96:99], v[108:111], v[40:43]
    ds_read_b64_tr_b16 v[126:127], v249 offset:15360
    s_cselect_b32 s57, s6, s7
    v_mfma_f32_16x16x32_bf16 v[44:47], v[96:99], v[112:115], v[44:47]
    ds_read_b64_tr_b16 v[128:129], v248 offset:10304
    s_cselect_b32 s18, 0, s18
    v_mfma_f32_16x16x32_bf16 v[48:51], v[96:99], v[116:119], v[48:51]
    ds_read_b64_tr_b16 v[130:131], v248 offset:15424
    v_mfma_f32_16x16x32_bf16 v[52:55], v[100:103], v[108:111], v[52:55]
    ds_read_b64_tr_b16 v[132:133], v249 offset:10304
    v_mfma_f32_16x16x32_bf16 v[56:59], v[100:103], v[112:115], v[56:59]
    ds_read_b64_tr_b16 v[134:135], v249 offset:15424
    v_mfma_f32_16x16x32_bf16 v[60:63], v[100:103], v[116:119], v[60:63]
    ds_read_b64_tr_b16 v[136:137], v248 offset:10368
    v_mfma_f32_16x16x32_bf16 v[64:67], v[104:107], v[108:111], v[64:67]
    ds_read_b64_tr_b16 v[138:139], v248 offset:15488
    s_cmp_eq_u32 s55, 2
    v_mfma_f32_16x16x32_bf16 v[68:71], v[104:107], v[112:115], v[68:71]
    v_add_u32 v248, s54, v248
    v_add_u32 v249, s54, v249
    v_mfma_f32_16x16x32_bf16 v[72:75], v[104:107], v[116:119], v[72:75]
    v_add_u32 v250, s57, v250
    s_waitcnt lgkmcnt(0)
    s_cbranch_scc0 L_p4bar
    s_barrier
    v_mfma_f32_16x16x32_bf16 v[16:19], v[120:123], v[140:143], v[16:19]
    v_mfma_f32_16x16x32_bf16 v[20:23], v[120:123], v[144:147], v[20:23]
    v_mfma_f32_16x16x32_bf16 v[24:27], v[120:123], v[148:151], v[24:27]
    v_mfma_f32_16x16x32_bf16 v[28:31], v[124:127], v[140:143], v[28:31]
    v_mfma_f32_16x16x32_bf16 v[32:35], v[124:127], v[144:147], v[32:35]
    v_mfma_f32_16x16x32_bf16 v[36:39], v[124:127], v[148:151], v[36:39]
    v_mfma_f32_16x16x32_bf16 v[40:43], v[128:131], v[140:143], v[40:43]
    v_mfma_f32_16x16x32_bf16 v[44:47], v[128:131], v[144:147], v[44:47]
    v_mfma_f32_16x16x32_bf16 v[48:51], v[128:131], v[148:151], v[48:51]
    v_mfma_f32_16x16x32_bf16 v[52:55], v[132:135], v[140:143], v[52:55]
    s_barrier
    ds_read_b128 v[108:111], v250 offset:0
    ds_read_b64_tr_b16 v[88:89], v248 offset:0
    v_mfma_f32_16x16x32_bf16 v[56:59], v[132:135], v[144:147], v[56:59]
    ds_read_b64_tr_b16 v[90:91], v248 offset:5120
    ds_read_b128 v[112:115], v250 offset:1024
    v_mfma_f32_16x16x32_bf16 v[60:63], v[132:135], v[148:151], v[60:63]
    ds_read_b128 v[116:119], v250 offset:2048
    ds_read_b64_tr_b16 v[92:93], v249 offset:0
    v_mfma_f32_16x16x32_bf16 v[64:67], v[136:139], v[140:143], v[64:67]
    ds_read_b64_tr_b16 v[94:95], v249 offset:5120
    ds_read_b64_tr_b16 v[96:97], v248 offset:64
    v_mfma_f32_16x16x32_bf16 v[68:71], v[136:139], v[144:147], v[68:71]
    ds_read_b64_tr_b16 v[98:99], v248 offset:5184
    ds_read_b64_tr_b16 v[100:101], v249 offset:64
    v_mfma_f32_16x16x32_bf16 v[72:75], v[136:139], v[148:151], v[72:75]
    ds_read_b64_tr_b16 v[102:103], v249 offset:5184
    ds_read_b64_tr_b16 v[104:105], v248 offset:128
    ds_read_b64_tr_b16 v[106:107], v248 offset:5248
    s_add_u32 s55, s55, 1
    s_waitcnt lgkmcnt(0)
    s_branch L_p4
L_p4bar:
    s_barrier
    v_mfma_f32_16x16x32_bf16 v[16:19], v[120:123], v[140:143], v[16:19]
    ds_read_b128 v[108:111], v250 offset:0
    v_mfma_f32_16x16x32_bf16 v[20:23], v[120:123], v[144:147], v[20:23]
    ds_read_b64_tr_b16 v[88:89], v248 offset:0
    v_mfma_f32_16x16x32_bf16 v[24:27], v[120:123], v[148:151], v[24:27]
    ds_read_b64_tr_b16 v[90:91], v248 offset:5120
    v_mfma_f32_16x16x32_bf16 v[28:31], v[124:127], v[140:143], v[28:31]
    ds_read_b128 v[112:115], v250 offset:1024
    v_mfma_f32_16x16x32_bf16 v[32:35], v[124:127], v[144:147], v[32:35]
    ds_read_b128 v[116:119], v250 offset:2048
    v_mfma_f32_16x16x32_bf16 v[36:39], v[124:127], v[148:151], v[36:39]
    ds_read_b64_tr_b16 v[92:93], v249 offset:0
    v_mfma_f32_16x16x32_bf16 v[40:43], v[128:131], v[140:143], v[40:43]
    ds_read_b64_tr_b16 v[94:95], v249 offset:5120
    v_mfma_f32_16x16x32_bf16 v[44:47], v[128:131], v[144:147], v[44:47]
    ds_read_b64_tr_b16 v[96:97], v248 offset:64
    v_mfma_f32_16x16x32_bf16 v[48:51], v[128:131], v[148:151], v[48:51]
    ds_read_b64_tr_b16 v[98:99], v248 offset:5184
    v_mfma_f32_16x16x32_bf16 v[52:55], v[132:135], v[140:143], v[52:55]
    ds_read_b64_tr_b16 v[100:101], v249 offset:64
    v_mfma_f32_16x16x32_bf16 v[56:59], v[132:135], v[144:147], v[56:59]
    ds_read_b64_tr_b16 v[102:103], v249 offset:5184
    v_mfma_f32_16x16x32_bf16 v[60:63], v[132:135], v[148:151], v[60:63]
    ds_read_b64_tr_b16 v[104:105], v248 offset:128
    v_mfma_f32_16x16x32_bf16 v[64:67], v[136:139], v[140:143], v[64:67]
    ds_read_b64_tr_b16 v[106:107], v248 offset:5248
    s_add_u32 s55, s55, 1
    v_mfma_f32_16x16x32_bf16 v[68:71], v[136:139], v[144:147], v[68:71]
    s_cmp_lt_u32 s55, 11
    v_mfma_f32_16x16x32_bf16 v[72:75], v[136:139], v[148:151], v[72:75]
    s_waitcnt lgkmcnt(0)
    s_cbranch_scc1 L_p4
    v_mfma_f32_16x16x32_bf16 v[16:19], v[88:91], v[108:111], v[16:19]
    ds_read_b128 v[140:143], v250 offset:6144
    v_mfma_f32_16x16x32_bf16 v[20:23], v[88:91], v[112:115], v[20:23]
    ds_read_b64_tr_b16 v[120:121], v248 offset:10240
    v_mfma_f32_16x16x32_bf16 v[24:27], v[88:91], v[116:119], v[24:27]
    ds_read_b64_tr_b16 v[122:123], v248 offset:15360
    v_mfma_f32_16x16x32_bf16 v[28:31], v[92:95], v[108:111], v[28:31]
    ds_read_b128 v[144:147], v250 offset:7168
    v_mfma_f32_16x16x32_bf16 v[32:35], v[92:95], v[112:115], v[32:35]
    ds_read_b128 v[148:151], v250 offset:8192
    v_mfma_f32_16x16x32_bf16 v[36:39], v[92:95], v[116:119], v[36:39]
    ds_read_b64_tr_b16 v[124:125], v249 offset:10240
    v_mfma_f32_16x16x32_bf16 v[40:43], v[96:99], v[108:111], v[40:43]
    ds_read_b64_tr_b16 v[126:127], v249 offset:15360
    v_mfma_f32_16x16x32_bf16 v[44:47], v[96:99], v[112:115], v[44:47]
    ds_read_b64_tr_b16 v[128:129], v248 offset:10304
    v_mfma_f32_16x16x32_bf16 v[48:51], v[96:99], v[116:119], v[48:51]
    ds_read_b64_tr_b16 v[130:131], v248 offset:15424
    v_mfma_f32_16x16x32_bf16 v[52:55], v[100:103], v[108:111], v[52:55]
    ds_read_b64_tr_b16 v[132:133], v249 offset:10304
    v_mfma_f32_16x16x32_bf16 v[56:59], v[100:103], v[112:115], v[56:59]
    ds_read_b64_tr_b16 v[134:135], v249 offset:15424
    v_mfma_f32_16x16x32_bf16 v[60:63], v[100:103], v[116:119], v[60:63]
    ds_read_b64_tr_b16 v[136:137], v248 offset:10368
    v_mfma_f32_16x16x32_bf16 v[64:67], v[104:107], v[108:111], v[64:67]
    ds_read_b64_tr_b16 v[138:139], v248 offset:15488
    v_mfma_f32_16x16x32_bf16 v[68:71], v[104:107], v[112:115], v[68:71]
    v_mfma_f32_16x16x32_bf16 v[72:75], v[104:107], v[116:119], v[72:75]
    s_waitcnt lgkmcnt(0)
    v_mfma_f32_16x16x32_bf16 v[16:19], v[120:123], v[140:143], v[16:19]
    v_mfma_f32_16x16x32_bf16 v[20:23], v[120:123], v[144:147], v[20:23]
    v_mfma_f32_16x16x32_bf16 v[24:27], v[120:123], v[148:151], v[24:27]
    v_mfma_f32_16x16x32_bf16 v[28:31], v[124:127], v[140:143], v[28:31]
    v_mfma_f32_16x16x32_bf16 v[32:35], v[124:127], v[144:147], v[32:35]
    v_mfma_f32_16x16x32_bf16 v[36:39], v[124:127], v[148:151], v[36:39]
    v_mfma_f32_16x16x32_bf16 v[40:43], v[128:131], v[140:143], v[40:43]
    v_mfma_f32_16x16x32_bf16 v[44:47], v[128:131], v[144:147], v[44:47]
    v_mfma_f32_16x16x32_bf16 v[48:51], v[128:131], v[148:151], v[48:51]
    v_mfma_f32_16x16x32_bf16 v[52:55], v[132:135], v[140:143], v[52:55]
    v_cvt_pk_bf16_f32 v160, v16, v17
    v_cvt_pk_bf16_f32 v161, v18, v19
    v_mfma_f32_16x16x32_bf16 v[56:59], v[132:135], v[144:147], v[56:59]
    v_cvt_pk_bf16_f32 v162, v28, v29
    v_cvt_pk_bf16_f32 v163, v30, v31
    v_mfma_f32_16x16x32_bf16 v[60:63], v[132:135], v[148:151], v[60:63]
    s_mov_b32 s3, 0
    buffer_store_dwordx4 v[160:163], v251, s[12:15], s3 offen sc1
    v_mfma_f32_16x16x32_bf16 v[64:67], v[136:139], v[140:143], v[64:67]
    v_cvt_pk_bf16_f32 v164, v20, v21
    v_cvt_pk_bf16_f32 v165, v22, v23
    v_mfma_f32_16x16x32_bf16 v[68:71], v[136:139], v[144:147], v[68:71]
    v_cvt_pk_bf16_f32 v166, v32, v33
    v_cvt_pk_bf16_f32 v167, v34, v35
    v_mfma_f32_16x16x32_bf16 v[72:75], v[136:139], v[148:151], v[72:75]
    s_mov_b32 s3, 2560
    buffer_store_dwordx4 v[164:167], v251, s[12:15], s3 offen sc1
    v_cvt_pk_bf16_f32 v168, v24, v25
    v_cvt_pk_bf16_f32 v169, v26, v27
    v_cvt_pk_bf16_f32 v170, v36, v37
    v_cvt_pk_bf16_f32 v171, v38, v39
    s_mov_b32 s3, 5120
    buffer_store_dwordx4 v[168:171], v251, s[12:15], s3 offen sc1
    v_cvt_pk_bf16_f32 v172, v40, v41
    v_cvt_pk_bf16_f32 v173, v42, v43
    v_cvt_pk_bf16_f32 v174, v52, v53
    v_cvt_pk_bf16_f32 v175, v54, v55
    s_mov_b32 s3, 1024
    buffer_store_dwordx4 v[172:175], v251, s[12:15], s3 offen sc1
    v_cvt_pk_bf16_f32 v176, v44, v45
    v_cvt_pk_bf16_f32 v177, v46, v47
    v_cvt_pk_bf16_f32 v178, v56, v57
    v_cvt_pk_bf16_f32 v179, v58, v59
    s_mov_b32 s3, 3584
    buffer_store_dwordx4 v[176:179], v251, s[12:15], s3 offen sc1
    v_cvt_pk_bf16_f32 v180, v48, v49
    v_cvt_pk_bf16_f32 v181, v50, v51
    v_cvt_pk_bf16_f32 v182, v60, v61
    v_cvt_pk_bf16_f32 v183, v62, v63
    s_mov_b32 s3, 6144
    buffer_store_dwordx4 v[180:183], v251, s[12:15], s3 offen sc1
    v_cvt_pk_bf16_f32 v184, v64, v65
    v_cvt_pk_bf16_f32 v185, v66, v67
    s_mov_b32 s3, 0
    buffer_store_dwordx2 v[184:185], v252, s[12:15], s3 offen sc1
    v_cvt_pk_bf16_f32 v186, v68, v69
    v_cvt_pk_bf16_f32 v187, v70, v71
    s_mov_b32 s3, 2560
    buffer_store_dwordx2 v[186:187], v252, s[12:15], s3 offen sc1
    v_cvt_pk_bf16_f32 v188, v72, v73
    v_cvt_pk_bf16_f32 v189, v74, v75
    s_mov_b32 s3, 5120
    buffer_store_dwordx2 v[188:189], v252, s[12:15], s3 offen sc1
    ds_write_b128 v251, v[160:163] offset:4096
    ds_write_b128 v251, v[164:167] offset:6656
    ds_write_b128 v251, v[168:171] offset:9216
    ds_write_b128 v251, v[172:175] offset:5120
    ds_write_b128 v251, v[176:179] offset:7680
    ds_write_b128 v251, v[180:183] offset:10240
    ds_write_b64 v252, v[184:185] offset:4096
    ds_write_b64 v252, v[186:187] offset:6656
    ds_write_b64 v252, v[188:189] offset:9216
    s_waitcnt lgkmcnt(0)
    s_barrier
    s_waitcnt vmcnt(0)
    s_mov_b64 exec, 15
    buffer_store_dwordx2 v[254:255], v253, s[24:27], s17 offen sc1
L_last:
    s_endpgm
.section .rodata,"a"
.p2align 6
.amdhsa_kernel standalone__gqa_block_cached__near_ridge_kernel
.amdhsa_next_free_vgpr 256
.amdhsa_next_free_sgpr 102
.amdhsa_accum_offset 256
.amdhsa_group_segment_fixed_size 0
.amdhsa_kernarg_size 64
.amdhsa_user_sgpr_count 2
.amdhsa_user_sgpr_kernarg_segment_ptr 1
.amdhsa_system_sgpr_workgroup_id_x 1
.amdhsa_float_denorm_mode_32 3
.end_amdhsa_kernel
```
